```python
import torch

def _softmax(x, axis=-1):
    return torch.softmax(x, dim=axis)
def _gelu(x):
    return torch.nn.functional.gelu(x, approximate="tanh")
def _silu(x):
    return torch.nn.functional.silu(x)
def _sigmoid(x):
    return torch.sigmoid(x)
def _layernorm(x, axis=-1, eps=1e-5):
    m = x.mean(dim=axis, keepdim=True)
    v = x.var(dim=axis, keepdim=True, unbiased=False)
    return (x - m) / torch.sqrt(v + eps)
def _scatter_add(tgt, idx, src, axis=0):
    return tgt.clone().index_add_(axis, idx, src)
def _segment_sum(src, seg, n):
    out = torch.zeros((n,) + src.shape[1:], dtype=src.dtype)
    return out.index_add_(0, seg, src)
def _pad(x, pw):
    flat = tuple(v for pair in reversed(pw) for v in pair)
    return torch.nn.functional.pad(x, flat)

kernel_name = 'concat_heads__mha_block_cached__compressed_kv_cla__decode'

def setup_inputs():

    _w = (lambda a: (lambda t: t.to(torch.bfloat16) if t.is_floating_point() else t)(torch.as_tensor(a)))
    def _A_setup():
        B, Sq, D = 2, 1, 512
        H, Sk, Dh = 32, 4096, 128
        return {
            "x": _w((lambda *s: torch.randn(*s, dtype=torch.bfloat16) * 1.6)(B, Sq, D)),
            "k_cache": _w((lambda *s: torch.randn(*s, dtype=torch.bfloat16) * 1.6)(B, H, Sk, Dh)),
            "v_cache": _w((lambda *s: torch.randn(*s, dtype=torch.bfloat16) * 0.05)(B, H, Sk, Dh)),
            "wq": _w((lambda *s: torch.randn(*s, dtype=torch.bfloat16) * 1.6)(D, H * Dh) * (D ** -0.5)),
            "wo": _w((lambda *s: torch.randn(*s, dtype=torch.bfloat16) * 0.05)(H * Dh, D) * ((H * Dh) ** -0.5)),
        }
    _A_in = _A_setup()

    def _B_setup():
        B, H, Sq, Sk, D, M = 2, 32, 1, 4096, 128, 512
        Dc = 4 * D
        return {
            "x": _w((lambda *s: torch.randn(*s, dtype=torch.bfloat16) * 3.2)(B, Sq, M)),
            "c_kv": _w((lambda *s: torch.randn(*s, dtype=torch.bfloat16) * 0.1)(B, Sk, Dc)),
            "w_q": _w((lambda *s: torch.randn(*s, dtype=torch.bfloat16) * 6.4)(M, H, D) * (M ** -0.5)),
            "w_uk": _w((lambda *s: torch.randn(*s, dtype=torch.bfloat16) * 6.4)(Dc, H, D) * (Dc ** -0.5)),
            "w_uv": _w((lambda *s: torch.randn(*s, dtype=torch.bfloat16) * 0.1)(Dc, H, D) * (Dc ** -0.5)),
            "w_o": _w((lambda *s: torch.randn(*s, dtype=torch.bfloat16) * 0.1)(H, D, M) * ((H * D) ** -0.5)),
        }
    _B_in = _B_setup()

    return {
        "A_x": _A_in["x"],
        "A_k_cache": _A_in["k_cache"],
        "A_v_cache": _A_in["v_cache"],
        "A_wq": _A_in["wq"],
        "A_wo": _A_in["wo"],
        "B_x": _B_in["x"],
        "B_c_kv": _B_in["c_kv"],
        "B_w_q": _B_in["w_q"],
        "B_w_uk": _B_in["w_uk"],
        "B_w_uv": _B_in["w_uv"],
        "B_w_o": _B_in["w_o"],
    }

def reference(A_x, A_k_cache, A_v_cache, A_wq, A_wo, B_x, B_c_kv, B_w_q, B_w_uk, B_w_uv, B_w_o):
    def _A_ref(x, k_cache, v_cache, wq, wo):
        B, Sq, D = x.shape
        H, Dh = 32, 128
        q = (lambda x, *d: x.permute(*d))((x @ wq).reshape(B, Sq, H, Dh), 0, 2, 1, 3)
        scores = torch.einsum("bhqd,bhkd->bhqk", q, k_cache) * (Dh ** -0.5)
        p = _softmax(scores, axis=-1)
        o = torch.einsum("bhqk,bhkd->bhqd", p, v_cache)
        return (lambda x, *d: x.permute(*d))(o, 0, 2, 1, 3).reshape(B, Sq, H * Dh) @ wo

    def _B_ref(x, c_kv, w_q, w_uk, w_uv, w_o):
        B, Sq, M = x.shape[0], x.shape[1], x.shape[2]
        Sk = c_kv.shape[1]
        H, D = w_q.shape[1], w_q.shape[2]
        q = torch.einsum("bqm,mhd->bhqd", x, w_q)
        k = torch.einsum("bkc,chd->bhkd", c_kv, w_uk)
        v = torch.einsum("bkc,chd->bhkd", c_kv, w_uv)
        scores = torch.einsum("bhqd,bhkd->bhqk", q, k) * (D ** -0.5)
        off = Sk - Sq
        qi = torch.arange(Sq)[:, None]
        kj = torch.arange(Sk)[None, :]
        cmask = kj <= (qi + off)
        scores = torch.where(cmask[None, None], scores, -1e9)
        p = _softmax(scores, axis=-1)
        ctx = torch.einsum("bhqk,bhkd->bhqd", p, v)
        return torch.einsum("bhqd,hdm->bqm", ctx, w_o)

    a = _A_ref(A_x, A_k_cache, A_v_cache, A_wq, A_wo)
    b = _B_ref(B_x, B_c_kv, B_w_q, B_w_uk, B_w_uv, B_w_o)
    return torch.concatenate([a, b], axis=-1)
```

```asm
; @launch kernel=main_kernel grid=(256,1,1) block=(512,1,1) lds=163840
.amdgcn_target "amdgcn-amd-amdhsa--gfx950"
.text
.globl main_kernel
.p2align 8
.type main_kernel,@function
main_kernel:
    s_cmp_ge_u32 s2, 256
    s_cbranch_scc1 main_end
    s_load_dwordx2 s[60:61], s[0:1], 96
    s_waitcnt lgkmcnt(0)
    s_mov_b32 s56, s60
    s_mov_b32 s57, s61
    s_mov_b32 s58, 256
    s_mov_b32 s59, 0x00020000
    s_cmp_ge_u32 s2, 64
    s_cbranch_scc1 main_A
    s_load_dwordx2 s[40:41], s[0:1], 40
    s_load_dwordx4 s[44:47], s[0:1], 56
    s_load_dwordx2 s[48:49], s[0:1], 104
    s_and_b32 s25, s2, 31
    s_lshr_b32 s27, s2, 5
    v_and_b32 v1, 63, v0
    v_lshrrev_b32 v48, 6, v0
    v_lshrrev_b32 v2, 4, v1
    v_and_b32 v3, 15, v1
    v_readfirstlane_b32 s24, v48
    v_lshrrev_b32 v4, 2, v1
    v_and_b32 v4, 3, v4
    v_and_b32 v5, 3, v1
    v_lshrrev_b32 v48, 1, v3
    v_and_b32 v49, 1, v3
    v_mov_b32 v50, 0xffff
    v_mov_b32 v51, 0xffff0000
    v_cmp_eq_u32 vcc, 1, v49
    s_nop 1
    v_cndmask_b32 v50, v50, v51, vcc
    v_mov_b32 v51, 0
    v_cmp_eq_u32 vcc, 0, v48
    s_nop 1
    v_cndmask_b32 v10, v51, v50, vcc
    v_cmp_eq_u32 vcc, 1, v48
    s_nop 1
    v_cndmask_b32 v11, v51, v50, vcc
    v_cmp_eq_u32 vcc, 2, v48
    s_nop 1
    v_cndmask_b32 v12, v51, v50, vcc
    v_cmp_eq_u32 vcc, 3, v48
    s_nop 1
    v_cndmask_b32 v13, v51, v50, vcc
    v_and_b32 v48, 2, v1
    v_cmp_ne_u32 s[32:33], 0, v48
    v_and_b32 v48, 1, v1
    v_cmp_ne_u32 s[34:35], 0, v48
    v_lshlrev_b32 v48, 4, v3
    v_lshl_add_u32 v8, v2, 13, v48
    v_lshlrev_b32 v6, 13, v4
    v_lshl_add_u32 v6, v2, 6, v6
    v_lshl_add_u32 v6, v5, 4, v6
    v_lshl_add_u32 v9, v3, 2, v2
    v_lshlrev_b32 v9, 1, v9
    v_lshl_add_u32 v7, v2, 2, v5
    v_lshl_add_u32 v7, v7, 2, v4
    v_lshlrev_b32 v7, 1, v7
    s_waitcnt lgkmcnt(0)
    s_mov_b32 s4, s44
    s_mov_b32 s5, s45
    s_mov_b32 s6, 4194304
    s_mov_b32 s7, 0x00020000
    s_mov_b32 s8, s46
    s_mov_b32 s9, s47
    s_mov_b32 s10, 4194304
    s_mov_b32 s11, 0x00020000
    s_mov_b32 s16, s40
    s_mov_b32 s17, s41
    s_mov_b32 s18, 2048
    s_mov_b32 s19, 0x00020000
    s_mov_b32 s20, s48
    s_mov_b32 s21, s49
    s_mov_b32 s22, 268435456
    s_mov_b32 s23, 0x00020000
    s_lshl_b32 s29, s24, 19
    s_lshl_b32 s31, s25, 8
    s_add_u32 s29, s29, s31
    s_lshl_b32 s28, s27, 21
    s_add_u32 s28, s28, s29
    s_lshl_b32 s30, s24, 7
    buffer_load_ushort v52, v9, s[16:19], s30 offen
    buffer_load_ushort v53, v9, s[16:19], s30 offen offset:1024
    buffer_load_dwordx4 v[64:67], v8, s[4:7], s29 offen
    s_add_u32 s29, s29, 32768
    buffer_load_dwordx4 v[68:71], v8, s[4:7], s29 offen
    s_add_u32 s29, s29, 32768
    buffer_load_dwordx4 v[72:75], v8, s[4:7], s29 offen
    s_add_u32 s29, s29, 32768
    buffer_load_dwordx4 v[76:79], v8, s[4:7], s29 offen
    s_add_u32 s29, s29, 32768
    buffer_load_dwordx4 v[80:83], v8, s[4:7], s29 offen
    s_add_u32 s29, s29, 32768
    buffer_load_dwordx4 v[84:87], v8, s[4:7], s29 offen
    s_add_u32 s29, s29, 32768
    buffer_load_dwordx4 v[88:91], v8, s[4:7], s29 offen
    s_add_u32 s29, s29, 32768
    buffer_load_dwordx4 v[92:95], v8, s[4:7], s29 offen
    s_add_u32 s29, s29, 32768
    buffer_load_dwordx4 v[96:99], v8, s[4:7], s29 offen
    s_add_u32 s29, s29, 32768
    buffer_load_dwordx4 v[100:103], v8, s[4:7], s29 offen
    s_add_u32 s29, s29, 32768
    buffer_load_dwordx4 v[104:107], v8, s[4:7], s29 offen
    s_add_u32 s29, s29, 32768
    buffer_load_dwordx4 v[108:111], v8, s[4:7], s29 offen
    s_add_u32 s29, s29, 32768
    buffer_load_dwordx4 v[112:115], v8, s[4:7], s29 offen
    s_add_u32 s29, s29, 32768
    buffer_load_dwordx4 v[116:119], v8, s[4:7], s29 offen
    s_add_u32 s29, s29, 32768
    buffer_load_dwordx4 v[120:123], v8, s[4:7], s29 offen
    s_add_u32 s29, s29, 32768
    buffer_load_dwordx4 v[124:127], v8, s[4:7], s29 offen
    s_cmp_ge_u32 s24, 4
    s_cbranch_scc1 B1_skipuk
    buffer_load_dwordx4 v[128:131], v6, s[8:11], s28 offen nt
    s_add_u32 s28, s28, 32768
    buffer_load_dwordx4 v[132:135], v6, s[8:11], s28 offen nt
    s_add_u32 s28, s28, 32768
    buffer_load_dwordx4 v[136:139], v6, s[8:11], s28 offen nt
    s_add_u32 s28, s28, 32768
    buffer_load_dwordx4 v[140:143], v6, s[8:11], s28 offen nt
    s_add_u32 s28, s28, 32768
    buffer_load_dwordx4 v[144:147], v6, s[8:11], s28 offen nt
    s_add_u32 s28, s28, 32768
    buffer_load_dwordx4 v[148:151], v6, s[8:11], s28 offen nt
    s_add_u32 s28, s28, 32768
    buffer_load_dwordx4 v[152:155], v6, s[8:11], s28 offen nt
    s_add_u32 s28, s28, 32768
    buffer_load_dwordx4 v[156:159], v6, s[8:11], s28 offen nt
    s_add_u32 s28, s28, 32768
    buffer_load_dwordx4 v[160:163], v6, s[8:11], s28 offen nt
    s_add_u32 s28, s28, 32768
    buffer_load_dwordx4 v[164:167], v6, s[8:11], s28 offen nt
    s_add_u32 s28, s28, 32768
    buffer_load_dwordx4 v[168:171], v6, s[8:11], s28 offen nt
    s_add_u32 s28, s28, 32768
    buffer_load_dwordx4 v[172:175], v6, s[8:11], s28 offen nt
    s_add_u32 s28, s28, 32768
    buffer_load_dwordx4 v[176:179], v6, s[8:11], s28 offen nt
    s_add_u32 s28, s28, 32768
    buffer_load_dwordx4 v[180:183], v6, s[8:11], s28 offen nt
    s_add_u32 s28, s28, 32768
    buffer_load_dwordx4 v[184:187], v6, s[8:11], s28 offen nt
    s_add_u32 s28, s28, 32768
    buffer_load_dwordx4 v[188:191], v6, s[8:11], s28 offen nt
B1_skipuk:
    s_cmp_ge_u32 s24, 4
    s_cbranch_scc1 B1_gemv_nouk
    s_waitcnt vmcnt(32)
    v_lshl_or_b32 v52, v52, 16, v52
    v_lshl_or_b32 v53, v53, 16, v53
    v_mov_b32 v24, 0
    v_mov_b32 v25, 0
    v_mov_b32 v26, 0
    v_mov_b32 v27, 0
    v_mov_b32 v56, 0
    v_mov_b32 v57, 0
    v_mov_b32 v58, 0
    v_mov_b32 v59, 0
    s_waitcnt vmcnt(31)
    v_and_b32_dpp v28, v52, v10 row_newbcast:0 row_mask:0xf bank_mask:0xf
    v_and_b32_dpp v29, v52, v11 row_newbcast:0 row_mask:0xf bank_mask:0xf
    v_and_b32_dpp v30, v52, v12 row_newbcast:0 row_mask:0xf bank_mask:0xf
    v_and_b32_dpp v31, v52, v13 row_newbcast:0 row_mask:0xf bank_mask:0xf
    s_nop 1
    v_mfma_f32_16x16x32_bf16 v[24:27], v[28:31], v[64:67], v[24:27]
    v_and_b32_dpp v28, v53, v10 row_newbcast:0 row_mask:0xf bank_mask:0xf
    v_and_b32_dpp v29, v53, v11 row_newbcast:0 row_mask:0xf bank_mask:0xf
    v_and_b32_dpp v30, v53, v12 row_newbcast:0 row_mask:0xf bank_mask:0xf
    v_and_b32_dpp v31, v53, v13 row_newbcast:0 row_mask:0xf bank_mask:0xf
    s_nop 1
    v_mfma_f32_16x16x32_bf16 v[56:59], v[28:31], v[64:67], v[56:59]
    s_waitcnt vmcnt(30)
    v_and_b32_dpp v28, v52, v10 row_newbcast:1 row_mask:0xf bank_mask:0xf
    v_and_b32_dpp v29, v52, v11 row_newbcast:1 row_mask:0xf bank_mask:0xf
    v_and_b32_dpp v30, v52, v12 row_newbcast:1 row_mask:0xf bank_mask:0xf
    v_and_b32_dpp v31, v52, v13 row_newbcast:1 row_mask:0xf bank_mask:0xf
    s_nop 1
    v_mfma_f32_16x16x32_bf16 v[24:27], v[28:31], v[68:71], v[24:27]
    v_and_b32_dpp v28, v53, v10 row_newbcast:1 row_mask:0xf bank_mask:0xf
    v_and_b32_dpp v29, v53, v11 row_newbcast:1 row_mask:0xf bank_mask:0xf
    v_and_b32_dpp v30, v53, v12 row_newbcast:1 row_mask:0xf bank_mask:0xf
    v_and_b32_dpp v31, v53, v13 row_newbcast:1 row_mask:0xf bank_mask:0xf
    s_nop 1
    v_mfma_f32_16x16x32_bf16 v[56:59], v[28:31], v[68:71], v[56:59]
    s_waitcnt vmcnt(29)
    v_and_b32_dpp v28, v52, v10 row_newbcast:2 row_mask:0xf bank_mask:0xf
    v_and_b32_dpp v29, v52, v11 row_newbcast:2 row_mask:0xf bank_mask:0xf
    v_and_b32_dpp v30, v52, v12 row_newbcast:2 row_mask:0xf bank_mask:0xf
    v_and_b32_dpp v31, v52, v13 row_newbcast:2 row_mask:0xf bank_mask:0xf
    s_nop 1
    v_mfma_f32_16x16x32_bf16 v[24:27], v[28:31], v[72:75], v[24:27]
    v_and_b32_dpp v28, v53, v10 row_newbcast:2 row_mask:0xf bank_mask:0xf
    v_and_b32_dpp v29, v53, v11 row_newbcast:2 row_mask:0xf bank_mask:0xf
    v_and_b32_dpp v30, v53, v12 row_newbcast:2 row_mask:0xf bank_mask:0xf
    v_and_b32_dpp v31, v53, v13 row_newbcast:2 row_mask:0xf bank_mask:0xf
    s_nop 1
    v_mfma_f32_16x16x32_bf16 v[56:59], v[28:31], v[72:75], v[56:59]
    s_waitcnt vmcnt(28)
    v_and_b32_dpp v28, v52, v10 row_newbcast:3 row_mask:0xf bank_mask:0xf
    v_and_b32_dpp v29, v52, v11 row_newbcast:3 row_mask:0xf bank_mask:0xf
    v_and_b32_dpp v30, v52, v12 row_newbcast:3 row_mask:0xf bank_mask:0xf
    v_and_b32_dpp v31, v52, v13 row_newbcast:3 row_mask:0xf bank_mask:0xf
    s_nop 1
    v_mfma_f32_16x16x32_bf16 v[24:27], v[28:31], v[76:79], v[24:27]
    v_and_b32_dpp v28, v53, v10 row_newbcast:3 row_mask:0xf bank_mask:0xf
    v_and_b32_dpp v29, v53, v11 row_newbcast:3 row_mask:0xf bank_mask:0xf
    v_and_b32_dpp v30, v53, v12 row_newbcast:3 row_mask:0xf bank_mask:0xf
    v_and_b32_dpp v31, v53, v13 row_newbcast:3 row_mask:0xf bank_mask:0xf
    s_nop 1
    v_mfma_f32_16x16x32_bf16 v[56:59], v[28:31], v[76:79], v[56:59]
    s_waitcnt vmcnt(27)
    v_and_b32_dpp v28, v52, v10 row_newbcast:4 row_mask:0xf bank_mask:0xf
    v_and_b32_dpp v29, v52, v11 row_newbcast:4 row_mask:0xf bank_mask:0xf
    v_and_b32_dpp v30, v52, v12 row_newbcast:4 row_mask:0xf bank_mask:0xf
    v_and_b32_dpp v31, v52, v13 row_newbcast:4 row_mask:0xf bank_mask:0xf
    s_nop 1
    v_mfma_f32_16x16x32_bf16 v[24:27], v[28:31], v[80:83], v[24:27]
    v_and_b32_dpp v28, v53, v10 row_newbcast:4 row_mask:0xf bank_mask:0xf
    v_and_b32_dpp v29, v53, v11 row_newbcast:4 row_mask:0xf bank_mask:0xf
    v_and_b32_dpp v30, v53, v12 row_newbcast:4 row_mask:0xf bank_mask:0xf
    v_and_b32_dpp v31, v53, v13 row_newbcast:4 row_mask:0xf bank_mask:0xf
    s_nop 1
    v_mfma_f32_16x16x32_bf16 v[56:59], v[28:31], v[80:83], v[56:59]
    s_waitcnt vmcnt(26)
    v_and_b32_dpp v28, v52, v10 row_newbcast:5 row_mask:0xf bank_mask:0xf
    v_and_b32_dpp v29, v52, v11 row_newbcast:5 row_mask:0xf bank_mask:0xf
    v_and_b32_dpp v30, v52, v12 row_newbcast:5 row_mask:0xf bank_mask:0xf
    v_and_b32_dpp v31, v52, v13 row_newbcast:5 row_mask:0xf bank_mask:0xf
    s_nop 1
    v_mfma_f32_16x16x32_bf16 v[24:27], v[28:31], v[84:87], v[24:27]
    v_and_b32_dpp v28, v53, v10 row_newbcast:5 row_mask:0xf bank_mask:0xf
    v_and_b32_dpp v29, v53, v11 row_newbcast:5 row_mask:0xf bank_mask:0xf
    v_and_b32_dpp v30, v53, v12 row_newbcast:5 row_mask:0xf bank_mask:0xf
    v_and_b32_dpp v31, v53, v13 row_newbcast:5 row_mask:0xf bank_mask:0xf
    s_nop 1
    v_mfma_f32_16x16x32_bf16 v[56:59], v[28:31], v[84:87], v[56:59]
    s_waitcnt vmcnt(25)
    v_and_b32_dpp v28, v52, v10 row_newbcast:6 row_mask:0xf bank_mask:0xf
    v_and_b32_dpp v29, v52, v11 row_newbcast:6 row_mask:0xf bank_mask:0xf
    v_and_b32_dpp v30, v52, v12 row_newbcast:6 row_mask:0xf bank_mask:0xf
    v_and_b32_dpp v31, v52, v13 row_newbcast:6 row_mask:0xf bank_mask:0xf
    s_nop 1
    v_mfma_f32_16x16x32_bf16 v[24:27], v[28:31], v[88:91], v[24:27]
    v_and_b32_dpp v28, v53, v10 row_newbcast:6 row_mask:0xf bank_mask:0xf
    v_and_b32_dpp v29, v53, v11 row_newbcast:6 row_mask:0xf bank_mask:0xf
    v_and_b32_dpp v30, v53, v12 row_newbcast:6 row_mask:0xf bank_mask:0xf
    v_and_b32_dpp v31, v53, v13 row_newbcast:6 row_mask:0xf bank_mask:0xf
    s_nop 1
    v_mfma_f32_16x16x32_bf16 v[56:59], v[28:31], v[88:91], v[56:59]
    s_waitcnt vmcnt(24)
    v_and_b32_dpp v28, v52, v10 row_newbcast:7 row_mask:0xf bank_mask:0xf
    v_and_b32_dpp v29, v52, v11 row_newbcast:7 row_mask:0xf bank_mask:0xf
    v_and_b32_dpp v30, v52, v12 row_newbcast:7 row_mask:0xf bank_mask:0xf
    v_and_b32_dpp v31, v52, v13 row_newbcast:7 row_mask:0xf bank_mask:0xf
    s_nop 1
    v_mfma_f32_16x16x32_bf16 v[24:27], v[28:31], v[92:95], v[24:27]
    v_and_b32_dpp v28, v53, v10 row_newbcast:7 row_mask:0xf bank_mask:0xf
    v_and_b32_dpp v29, v53, v11 row_newbcast:7 row_mask:0xf bank_mask:0xf
    v_and_b32_dpp v30, v53, v12 row_newbcast:7 row_mask:0xf bank_mask:0xf
    v_and_b32_dpp v31, v53, v13 row_newbcast:7 row_mask:0xf bank_mask:0xf
    s_nop 1
    v_mfma_f32_16x16x32_bf16 v[56:59], v[28:31], v[92:95], v[56:59]
    s_waitcnt vmcnt(23)
    v_and_b32_dpp v28, v52, v10 row_newbcast:8 row_mask:0xf bank_mask:0xf
    v_and_b32_dpp v29, v52, v11 row_newbcast:8 row_mask:0xf bank_mask:0xf
    v_and_b32_dpp v30, v52, v12 row_newbcast:8 row_mask:0xf bank_mask:0xf
    v_and_b32_dpp v31, v52, v13 row_newbcast:8 row_mask:0xf bank_mask:0xf
    s_nop 1
    v_mfma_f32_16x16x32_bf16 v[24:27], v[28:31], v[96:99], v[24:27]
    v_and_b32_dpp v28, v53, v10 row_newbcast:8 row_mask:0xf bank_mask:0xf
    v_and_b32_dpp v29, v53, v11 row_newbcast:8 row_mask:0xf bank_mask:0xf
    v_and_b32_dpp v30, v53, v12 row_newbcast:8 row_mask:0xf bank_mask:0xf
    v_and_b32_dpp v31, v53, v13 row_newbcast:8 row_mask:0xf bank_mask:0xf
    s_nop 1
    v_mfma_f32_16x16x32_bf16 v[56:59], v[28:31], v[96:99], v[56:59]
    s_waitcnt vmcnt(22)
    v_and_b32_dpp v28, v52, v10 row_newbcast:9 row_mask:0xf bank_mask:0xf
    v_and_b32_dpp v29, v52, v11 row_newbcast:9 row_mask:0xf bank_mask:0xf
    v_and_b32_dpp v30, v52, v12 row_newbcast:9 row_mask:0xf bank_mask:0xf
    v_and_b32_dpp v31, v52, v13 row_newbcast:9 row_mask:0xf bank_mask:0xf
    s_nop 1
    v_mfma_f32_16x16x32_bf16 v[24:27], v[28:31], v[100:103], v[24:27]
    v_and_b32_dpp v28, v53, v10 row_newbcast:9 row_mask:0xf bank_mask:0xf
    v_and_b32_dpp v29, v53, v11 row_newbcast:9 row_mask:0xf bank_mask:0xf
    v_and_b32_dpp v30, v53, v12 row_newbcast:9 row_mask:0xf bank_mask:0xf
    v_and_b32_dpp v31, v53, v13 row_newbcast:9 row_mask:0xf bank_mask:0xf
    s_nop 1
    v_mfma_f32_16x16x32_bf16 v[56:59], v[28:31], v[100:103], v[56:59]
    s_waitcnt vmcnt(21)
    v_and_b32_dpp v28, v52, v10 row_newbcast:10 row_mask:0xf bank_mask:0xf
    v_and_b32_dpp v29, v52, v11 row_newbcast:10 row_mask:0xf bank_mask:0xf
    v_and_b32_dpp v30, v52, v12 row_newbcast:10 row_mask:0xf bank_mask:0xf
    v_and_b32_dpp v31, v52, v13 row_newbcast:10 row_mask:0xf bank_mask:0xf
    s_nop 1
    v_mfma_f32_16x16x32_bf16 v[24:27], v[28:31], v[104:107], v[24:27]
    v_and_b32_dpp v28, v53, v10 row_newbcast:10 row_mask:0xf bank_mask:0xf
    v_and_b32_dpp v29, v53, v11 row_newbcast:10 row_mask:0xf bank_mask:0xf
    v_and_b32_dpp v30, v53, v12 row_newbcast:10 row_mask:0xf bank_mask:0xf
    v_and_b32_dpp v31, v53, v13 row_newbcast:10 row_mask:0xf bank_mask:0xf
    s_nop 1
    v_mfma_f32_16x16x32_bf16 v[56:59], v[28:31], v[104:107], v[56:59]
    s_waitcnt vmcnt(20)
    v_and_b32_dpp v28, v52, v10 row_newbcast:11 row_mask:0xf bank_mask:0xf
    v_and_b32_dpp v29, v52, v11 row_newbcast:11 row_mask:0xf bank_mask:0xf
    v_and_b32_dpp v30, v52, v12 row_newbcast:11 row_mask:0xf bank_mask:0xf
    v_and_b32_dpp v31, v52, v13 row_newbcast:11 row_mask:0xf bank_mask:0xf
    s_nop 1
    v_mfma_f32_16x16x32_bf16 v[24:27], v[28:31], v[108:111], v[24:27]
    v_and_b32_dpp v28, v53, v10 row_newbcast:11 row_mask:0xf bank_mask:0xf
    v_and_b32_dpp v29, v53, v11 row_newbcast:11 row_mask:0xf bank_mask:0xf
    v_and_b32_dpp v30, v53, v12 row_newbcast:11 row_mask:0xf bank_mask:0xf
    v_and_b32_dpp v31, v53, v13 row_newbcast:11 row_mask:0xf bank_mask:0xf
    s_nop 1
    v_mfma_f32_16x16x32_bf16 v[56:59], v[28:31], v[108:111], v[56:59]
    s_waitcnt vmcnt(19)
    v_and_b32_dpp v28, v52, v10 row_newbcast:12 row_mask:0xf bank_mask:0xf
    v_and_b32_dpp v29, v52, v11 row_newbcast:12 row_mask:0xf bank_mask:0xf
    v_and_b32_dpp v30, v52, v12 row_newbcast:12 row_mask:0xf bank_mask:0xf
    v_and_b32_dpp v31, v52, v13 row_newbcast:12 row_mask:0xf bank_mask:0xf
    s_nop 1
    v_mfma_f32_16x16x32_bf16 v[24:27], v[28:31], v[112:115], v[24:27]
    v_and_b32_dpp v28, v53, v10 row_newbcast:12 row_mask:0xf bank_mask:0xf
    v_and_b32_dpp v29, v53, v11 row_newbcast:12 row_mask:0xf bank_mask:0xf
    v_and_b32_dpp v30, v53, v12 row_newbcast:12 row_mask:0xf bank_mask:0xf
    v_and_b32_dpp v31, v53, v13 row_newbcast:12 row_mask:0xf bank_mask:0xf
    s_nop 1
    v_mfma_f32_16x16x32_bf16 v[56:59], v[28:31], v[112:115], v[56:59]
    s_waitcnt vmcnt(18)
    v_and_b32_dpp v28, v52, v10 row_newbcast:13 row_mask:0xf bank_mask:0xf
    v_and_b32_dpp v29, v52, v11 row_newbcast:13 row_mask:0xf bank_mask:0xf
    v_and_b32_dpp v30, v52, v12 row_newbcast:13 row_mask:0xf bank_mask:0xf
    v_and_b32_dpp v31, v52, v13 row_newbcast:13 row_mask:0xf bank_mask:0xf
    s_nop 1
    v_mfma_f32_16x16x32_bf16 v[24:27], v[28:31], v[116:119], v[24:27]
    v_and_b32_dpp v28, v53, v10 row_newbcast:13 row_mask:0xf bank_mask:0xf
    v_and_b32_dpp v29, v53, v11 row_newbcast:13 row_mask:0xf bank_mask:0xf
    v_and_b32_dpp v30, v53, v12 row_newbcast:13 row_mask:0xf bank_mask:0xf
    v_and_b32_dpp v31, v53, v13 row_newbcast:13 row_mask:0xf bank_mask:0xf
    s_nop 1
    v_mfma_f32_16x16x32_bf16 v[56:59], v[28:31], v[116:119], v[56:59]
    s_waitcnt vmcnt(17)
    v_and_b32_dpp v28, v52, v10 row_newbcast:14 row_mask:0xf bank_mask:0xf
    v_and_b32_dpp v29, v52, v11 row_newbcast:14 row_mask:0xf bank_mask:0xf
    v_and_b32_dpp v30, v52, v12 row_newbcast:14 row_mask:0xf bank_mask:0xf
    v_and_b32_dpp v31, v52, v13 row_newbcast:14 row_mask:0xf bank_mask:0xf
    s_nop 1
    v_mfma_f32_16x16x32_bf16 v[24:27], v[28:31], v[120:123], v[24:27]
    v_and_b32_dpp v28, v53, v10 row_newbcast:14 row_mask:0xf bank_mask:0xf
    v_and_b32_dpp v29, v53, v11 row_newbcast:14 row_mask:0xf bank_mask:0xf
    v_and_b32_dpp v30, v53, v12 row_newbcast:14 row_mask:0xf bank_mask:0xf
    v_and_b32_dpp v31, v53, v13 row_newbcast:14 row_mask:0xf bank_mask:0xf
    s_nop 1
    v_mfma_f32_16x16x32_bf16 v[56:59], v[28:31], v[120:123], v[56:59]
    s_waitcnt vmcnt(16)
    v_and_b32_dpp v28, v52, v10 row_newbcast:15 row_mask:0xf bank_mask:0xf
    v_and_b32_dpp v29, v52, v11 row_newbcast:15 row_mask:0xf bank_mask:0xf
    v_and_b32_dpp v30, v52, v12 row_newbcast:15 row_mask:0xf bank_mask:0xf
    v_and_b32_dpp v31, v52, v13 row_newbcast:15 row_mask:0xf bank_mask:0xf
    s_nop 1
    v_mfma_f32_16x16x32_bf16 v[24:27], v[28:31], v[124:127], v[24:27]
    v_and_b32_dpp v28, v53, v10 row_newbcast:15 row_mask:0xf bank_mask:0xf
    v_and_b32_dpp v29, v53, v11 row_newbcast:15 row_mask:0xf bank_mask:0xf
    v_and_b32_dpp v30, v53, v12 row_newbcast:15 row_mask:0xf bank_mask:0xf
    v_and_b32_dpp v31, v53, v13 row_newbcast:15 row_mask:0xf bank_mask:0xf
    s_nop 1
    v_mfma_f32_16x16x32_bf16 v[56:59], v[28:31], v[124:127], v[56:59]
    s_branch B1_gemv_done
B1_gemv_nouk:
    s_waitcnt vmcnt(16)
    v_lshl_or_b32 v52, v52, 16, v52
    v_lshl_or_b32 v53, v53, 16, v53
    v_mov_b32 v24, 0
    v_mov_b32 v25, 0
    v_mov_b32 v26, 0
    v_mov_b32 v27, 0
    v_mov_b32 v56, 0
    v_mov_b32 v57, 0
    v_mov_b32 v58, 0
    v_mov_b32 v59, 0
    s_waitcnt vmcnt(15)
    v_and_b32_dpp v28, v52, v10 row_newbcast:0 row_mask:0xf bank_mask:0xf
    v_and_b32_dpp v29, v52, v11 row_newbcast:0 row_mask:0xf bank_mask:0xf
    v_and_b32_dpp v30, v52, v12 row_newbcast:0 row_mask:0xf bank_mask:0xf
    v_and_b32_dpp v31, v52, v13 row_newbcast:0 row_mask:0xf bank_mask:0xf
    s_nop 1
    v_mfma_f32_16x16x32_bf16 v[24:27], v[28:31], v[64:67], v[24:27]
    v_and_b32_dpp v28, v53, v10 row_newbcast:0 row_mask:0xf bank_mask:0xf
    v_and_b32_dpp v29, v53, v11 row_newbcast:0 row_mask:0xf bank_mask:0xf
    v_and_b32_dpp v30, v53, v12 row_newbcast:0 row_mask:0xf bank_mask:0xf
    v_and_b32_dpp v31, v53, v13 row_newbcast:0 row_mask:0xf bank_mask:0xf
    s_nop 1
    v_mfma_f32_16x16x32_bf16 v[56:59], v[28:31], v[64:67], v[56:59]
    s_waitcnt vmcnt(14)
    v_and_b32_dpp v28, v52, v10 row_newbcast:1 row_mask:0xf bank_mask:0xf
    v_and_b32_dpp v29, v52, v11 row_newbcast:1 row_mask:0xf bank_mask:0xf
    v_and_b32_dpp v30, v52, v12 row_newbcast:1 row_mask:0xf bank_mask:0xf
    v_and_b32_dpp v31, v52, v13 row_newbcast:1 row_mask:0xf bank_mask:0xf
    s_nop 1
    v_mfma_f32_16x16x32_bf16 v[24:27], v[28:31], v[68:71], v[24:27]
    v_and_b32_dpp v28, v53, v10 row_newbcast:1 row_mask:0xf bank_mask:0xf
    v_and_b32_dpp v29, v53, v11 row_newbcast:1 row_mask:0xf bank_mask:0xf
    v_and_b32_dpp v30, v53, v12 row_newbcast:1 row_mask:0xf bank_mask:0xf
    v_and_b32_dpp v31, v53, v13 row_newbcast:1 row_mask:0xf bank_mask:0xf
    s_nop 1
    v_mfma_f32_16x16x32_bf16 v[56:59], v[28:31], v[68:71], v[56:59]
    s_waitcnt vmcnt(13)
    v_and_b32_dpp v28, v52, v10 row_newbcast:2 row_mask:0xf bank_mask:0xf
    v_and_b32_dpp v29, v52, v11 row_newbcast:2 row_mask:0xf bank_mask:0xf
    v_and_b32_dpp v30, v52, v12 row_newbcast:2 row_mask:0xf bank_mask:0xf
    v_and_b32_dpp v31, v52, v13 row_newbcast:2 row_mask:0xf bank_mask:0xf
    s_nop 1
    v_mfma_f32_16x16x32_bf16 v[24:27], v[28:31], v[72:75], v[24:27]
    v_and_b32_dpp v28, v53, v10 row_newbcast:2 row_mask:0xf bank_mask:0xf
    v_and_b32_dpp v29, v53, v11 row_newbcast:2 row_mask:0xf bank_mask:0xf
    v_and_b32_dpp v30, v53, v12 row_newbcast:2 row_mask:0xf bank_mask:0xf
    v_and_b32_dpp v31, v53, v13 row_newbcast:2 row_mask:0xf bank_mask:0xf
    s_nop 1
    v_mfma_f32_16x16x32_bf16 v[56:59], v[28:31], v[72:75], v[56:59]
    s_waitcnt vmcnt(12)
    v_and_b32_dpp v28, v52, v10 row_newbcast:3 row_mask:0xf bank_mask:0xf
    v_and_b32_dpp v29, v52, v11 row_newbcast:3 row_mask:0xf bank_mask:0xf
    v_and_b32_dpp v30, v52, v12 row_newbcast:3 row_mask:0xf bank_mask:0xf
    v_and_b32_dpp v31, v52, v13 row_newbcast:3 row_mask:0xf bank_mask:0xf
    s_nop 1
    v_mfma_f32_16x16x32_bf16 v[24:27], v[28:31], v[76:79], v[24:27]
    v_and_b32_dpp v28, v53, v10 row_newbcast:3 row_mask:0xf bank_mask:0xf
    v_and_b32_dpp v29, v53, v11 row_newbcast:3 row_mask:0xf bank_mask:0xf
    v_and_b32_dpp v30, v53, v12 row_newbcast:3 row_mask:0xf bank_mask:0xf
    v_and_b32_dpp v31, v53, v13 row_newbcast:3 row_mask:0xf bank_mask:0xf
    s_nop 1
    v_mfma_f32_16x16x32_bf16 v[56:59], v[28:31], v[76:79], v[56:59]
    s_waitcnt vmcnt(11)
    v_and_b32_dpp v28, v52, v10 row_newbcast:4 row_mask:0xf bank_mask:0xf
    v_and_b32_dpp v29, v52, v11 row_newbcast:4 row_mask:0xf bank_mask:0xf
    v_and_b32_dpp v30, v52, v12 row_newbcast:4 row_mask:0xf bank_mask:0xf
    v_and_b32_dpp v31, v52, v13 row_newbcast:4 row_mask:0xf bank_mask:0xf
    s_nop 1
    v_mfma_f32_16x16x32_bf16 v[24:27], v[28:31], v[80:83], v[24:27]
    v_and_b32_dpp v28, v53, v10 row_newbcast:4 row_mask:0xf bank_mask:0xf
    v_and_b32_dpp v29, v53, v11 row_newbcast:4 row_mask:0xf bank_mask:0xf
    v_and_b32_dpp v30, v53, v12 row_newbcast:4 row_mask:0xf bank_mask:0xf
    v_and_b32_dpp v31, v53, v13 row_newbcast:4 row_mask:0xf bank_mask:0xf
    s_nop 1
    v_mfma_f32_16x16x32_bf16 v[56:59], v[28:31], v[80:83], v[56:59]
    s_waitcnt vmcnt(10)
    v_and_b32_dpp v28, v52, v10 row_newbcast:5 row_mask:0xf bank_mask:0xf
    v_and_b32_dpp v29, v52, v11 row_newbcast:5 row_mask:0xf bank_mask:0xf
    v_and_b32_dpp v30, v52, v12 row_newbcast:5 row_mask:0xf bank_mask:0xf
    v_and_b32_dpp v31, v52, v13 row_newbcast:5 row_mask:0xf bank_mask:0xf
    s_nop 1
    v_mfma_f32_16x16x32_bf16 v[24:27], v[28:31], v[84:87], v[24:27]
    v_and_b32_dpp v28, v53, v10 row_newbcast:5 row_mask:0xf bank_mask:0xf
    v_and_b32_dpp v29, v53, v11 row_newbcast:5 row_mask:0xf bank_mask:0xf
    v_and_b32_dpp v30, v53, v12 row_newbcast:5 row_mask:0xf bank_mask:0xf
    v_and_b32_dpp v31, v53, v13 row_newbcast:5 row_mask:0xf bank_mask:0xf
    s_nop 1
    v_mfma_f32_16x16x32_bf16 v[56:59], v[28:31], v[84:87], v[56:59]
    s_waitcnt vmcnt(9)
    v_and_b32_dpp v28, v52, v10 row_newbcast:6 row_mask:0xf bank_mask:0xf
    v_and_b32_dpp v29, v52, v11 row_newbcast:6 row_mask:0xf bank_mask:0xf
    v_and_b32_dpp v30, v52, v12 row_newbcast:6 row_mask:0xf bank_mask:0xf
    v_and_b32_dpp v31, v52, v13 row_newbcast:6 row_mask:0xf bank_mask:0xf
    s_nop 1
    v_mfma_f32_16x16x32_bf16 v[24:27], v[28:31], v[88:91], v[24:27]
    v_and_b32_dpp v28, v53, v10 row_newbcast:6 row_mask:0xf bank_mask:0xf
    v_and_b32_dpp v29, v53, v11 row_newbcast:6 row_mask:0xf bank_mask:0xf
    v_and_b32_dpp v30, v53, v12 row_newbcast:6 row_mask:0xf bank_mask:0xf
    v_and_b32_dpp v31, v53, v13 row_newbcast:6 row_mask:0xf bank_mask:0xf
    s_nop 1
    v_mfma_f32_16x16x32_bf16 v[56:59], v[28:31], v[88:91], v[56:59]
    s_waitcnt vmcnt(8)
    v_and_b32_dpp v28, v52, v10 row_newbcast:7 row_mask:0xf bank_mask:0xf
    v_and_b32_dpp v29, v52, v11 row_newbcast:7 row_mask:0xf bank_mask:0xf
    v_and_b32_dpp v30, v52, v12 row_newbcast:7 row_mask:0xf bank_mask:0xf
    v_and_b32_dpp v31, v52, v13 row_newbcast:7 row_mask:0xf bank_mask:0xf
    s_nop 1
    v_mfma_f32_16x16x32_bf16 v[24:27], v[28:31], v[92:95], v[24:27]
    v_and_b32_dpp v28, v53, v10 row_newbcast:7 row_mask:0xf bank_mask:0xf
    v_and_b32_dpp v29, v53, v11 row_newbcast:7 row_mask:0xf bank_mask:0xf
    v_and_b32_dpp v30, v53, v12 row_newbcast:7 row_mask:0xf bank_mask:0xf
    v_and_b32_dpp v31, v53, v13 row_newbcast:7 row_mask:0xf bank_mask:0xf
    s_nop 1
    v_mfma_f32_16x16x32_bf16 v[56:59], v[28:31], v[92:95], v[56:59]
    s_waitcnt vmcnt(7)
    v_and_b32_dpp v28, v52, v10 row_newbcast:8 row_mask:0xf bank_mask:0xf
    v_and_b32_dpp v29, v52, v11 row_newbcast:8 row_mask:0xf bank_mask:0xf
    v_and_b32_dpp v30, v52, v12 row_newbcast:8 row_mask:0xf bank_mask:0xf
    v_and_b32_dpp v31, v52, v13 row_newbcast:8 row_mask:0xf bank_mask:0xf
    s_nop 1
    v_mfma_f32_16x16x32_bf16 v[24:27], v[28:31], v[96:99], v[24:27]
    v_and_b32_dpp v28, v53, v10 row_newbcast:8 row_mask:0xf bank_mask:0xf
    v_and_b32_dpp v29, v53, v11 row_newbcast:8 row_mask:0xf bank_mask:0xf
    v_and_b32_dpp v30, v53, v12 row_newbcast:8 row_mask:0xf bank_mask:0xf
    v_and_b32_dpp v31, v53, v13 row_newbcast:8 row_mask:0xf bank_mask:0xf
    s_nop 1
    v_mfma_f32_16x16x32_bf16 v[56:59], v[28:31], v[96:99], v[56:59]
    s_waitcnt vmcnt(6)
    v_and_b32_dpp v28, v52, v10 row_newbcast:9 row_mask:0xf bank_mask:0xf
    v_and_b32_dpp v29, v52, v11 row_newbcast:9 row_mask:0xf bank_mask:0xf
    v_and_b32_dpp v30, v52, v12 row_newbcast:9 row_mask:0xf bank_mask:0xf
    v_and_b32_dpp v31, v52, v13 row_newbcast:9 row_mask:0xf bank_mask:0xf
    s_nop 1
    v_mfma_f32_16x16x32_bf16 v[24:27], v[28:31], v[100:103], v[24:27]
    v_and_b32_dpp v28, v53, v10 row_newbcast:9 row_mask:0xf bank_mask:0xf
    v_and_b32_dpp v29, v53, v11 row_newbcast:9 row_mask:0xf bank_mask:0xf
    v_and_b32_dpp v30, v53, v12 row_newbcast:9 row_mask:0xf bank_mask:0xf
    v_and_b32_dpp v31, v53, v13 row_newbcast:9 row_mask:0xf bank_mask:0xf
    s_nop 1
    v_mfma_f32_16x16x32_bf16 v[56:59], v[28:31], v[100:103], v[56:59]
    s_waitcnt vmcnt(5)
    v_and_b32_dpp v28, v52, v10 row_newbcast:10 row_mask:0xf bank_mask:0xf
    v_and_b32_dpp v29, v52, v11 row_newbcast:10 row_mask:0xf bank_mask:0xf
    v_and_b32_dpp v30, v52, v12 row_newbcast:10 row_mask:0xf bank_mask:0xf
    v_and_b32_dpp v31, v52, v13 row_newbcast:10 row_mask:0xf bank_mask:0xf
    s_nop 1
    v_mfma_f32_16x16x32_bf16 v[24:27], v[28:31], v[104:107], v[24:27]
    v_and_b32_dpp v28, v53, v10 row_newbcast:10 row_mask:0xf bank_mask:0xf
    v_and_b32_dpp v29, v53, v11 row_newbcast:10 row_mask:0xf bank_mask:0xf
    v_and_b32_dpp v30, v53, v12 row_newbcast:10 row_mask:0xf bank_mask:0xf
    v_and_b32_dpp v31, v53, v13 row_newbcast:10 row_mask:0xf bank_mask:0xf
    s_nop 1
    v_mfma_f32_16x16x32_bf16 v[56:59], v[28:31], v[104:107], v[56:59]
    s_waitcnt vmcnt(4)
    v_and_b32_dpp v28, v52, v10 row_newbcast:11 row_mask:0xf bank_mask:0xf
    v_and_b32_dpp v29, v52, v11 row_newbcast:11 row_mask:0xf bank_mask:0xf
    v_and_b32_dpp v30, v52, v12 row_newbcast:11 row_mask:0xf bank_mask:0xf
    v_and_b32_dpp v31, v52, v13 row_newbcast:11 row_mask:0xf bank_mask:0xf
    s_nop 1
    v_mfma_f32_16x16x32_bf16 v[24:27], v[28:31], v[108:111], v[24:27]
    v_and_b32_dpp v28, v53, v10 row_newbcast:11 row_mask:0xf bank_mask:0xf
    v_and_b32_dpp v29, v53, v11 row_newbcast:11 row_mask:0xf bank_mask:0xf
    v_and_b32_dpp v30, v53, v12 row_newbcast:11 row_mask:0xf bank_mask:0xf
    v_and_b32_dpp v31, v53, v13 row_newbcast:11 row_mask:0xf bank_mask:0xf
    s_nop 1
    v_mfma_f32_16x16x32_bf16 v[56:59], v[28:31], v[108:111], v[56:59]
    s_waitcnt vmcnt(3)
    v_and_b32_dpp v28, v52, v10 row_newbcast:12 row_mask:0xf bank_mask:0xf
    v_and_b32_dpp v29, v52, v11 row_newbcast:12 row_mask:0xf bank_mask:0xf
    v_and_b32_dpp v30, v52, v12 row_newbcast:12 row_mask:0xf bank_mask:0xf
    v_and_b32_dpp v31, v52, v13 row_newbcast:12 row_mask:0xf bank_mask:0xf
    s_nop 1
    v_mfma_f32_16x16x32_bf16 v[24:27], v[28:31], v[112:115], v[24:27]
    v_and_b32_dpp v28, v53, v10 row_newbcast:12 row_mask:0xf bank_mask:0xf
    v_and_b32_dpp v29, v53, v11 row_newbcast:12 row_mask:0xf bank_mask:0xf
    v_and_b32_dpp v30, v53, v12 row_newbcast:12 row_mask:0xf bank_mask:0xf
    v_and_b32_dpp v31, v53, v13 row_newbcast:12 row_mask:0xf bank_mask:0xf
    s_nop 1
    v_mfma_f32_16x16x32_bf16 v[56:59], v[28:31], v[112:115], v[56:59]
    s_waitcnt vmcnt(2)
    v_and_b32_dpp v28, v52, v10 row_newbcast:13 row_mask:0xf bank_mask:0xf
    v_and_b32_dpp v29, v52, v11 row_newbcast:13 row_mask:0xf bank_mask:0xf
    v_and_b32_dpp v30, v52, v12 row_newbcast:13 row_mask:0xf bank_mask:0xf
    v_and_b32_dpp v31, v52, v13 row_newbcast:13 row_mask:0xf bank_mask:0xf
    s_nop 1
    v_mfma_f32_16x16x32_bf16 v[24:27], v[28:31], v[116:119], v[24:27]
    v_and_b32_dpp v28, v53, v10 row_newbcast:13 row_mask:0xf bank_mask:0xf
    v_and_b32_dpp v29, v53, v11 row_newbcast:13 row_mask:0xf bank_mask:0xf
    v_and_b32_dpp v30, v53, v12 row_newbcast:13 row_mask:0xf bank_mask:0xf
    v_and_b32_dpp v31, v53, v13 row_newbcast:13 row_mask:0xf bank_mask:0xf
    s_nop 1
    v_mfma_f32_16x16x32_bf16 v[56:59], v[28:31], v[116:119], v[56:59]
    s_waitcnt vmcnt(1)
    v_and_b32_dpp v28, v52, v10 row_newbcast:14 row_mask:0xf bank_mask:0xf
    v_and_b32_dpp v29, v52, v11 row_newbcast:14 row_mask:0xf bank_mask:0xf
    v_and_b32_dpp v30, v52, v12 row_newbcast:14 row_mask:0xf bank_mask:0xf
    v_and_b32_dpp v31, v52, v13 row_newbcast:14 row_mask:0xf bank_mask:0xf
    s_nop 1
    v_mfma_f32_16x16x32_bf16 v[24:27], v[28:31], v[120:123], v[24:27]
    v_and_b32_dpp v28, v53, v10 row_newbcast:14 row_mask:0xf bank_mask:0xf
    v_and_b32_dpp v29, v53, v11 row_newbcast:14 row_mask:0xf bank_mask:0xf
    v_and_b32_dpp v30, v53, v12 row_newbcast:14 row_mask:0xf bank_mask:0xf
    v_and_b32_dpp v31, v53, v13 row_newbcast:14 row_mask:0xf bank_mask:0xf
    s_nop 1
    v_mfma_f32_16x16x32_bf16 v[56:59], v[28:31], v[120:123], v[56:59]
    s_waitcnt vmcnt(0)
    v_and_b32_dpp v28, v52, v10 row_newbcast:15 row_mask:0xf bank_mask:0xf
    v_and_b32_dpp v29, v52, v11 row_newbcast:15 row_mask:0xf bank_mask:0xf
    v_and_b32_dpp v30, v52, v12 row_newbcast:15 row_mask:0xf bank_mask:0xf
    v_and_b32_dpp v31, v52, v13 row_newbcast:15 row_mask:0xf bank_mask:0xf
    s_nop 1
    v_mfma_f32_16x16x32_bf16 v[24:27], v[28:31], v[124:127], v[24:27]
    v_and_b32_dpp v28, v53, v10 row_newbcast:15 row_mask:0xf bank_mask:0xf
    v_and_b32_dpp v29, v53, v11 row_newbcast:15 row_mask:0xf bank_mask:0xf
    v_and_b32_dpp v30, v53, v12 row_newbcast:15 row_mask:0xf bank_mask:0xf
    v_and_b32_dpp v31, v53, v13 row_newbcast:15 row_mask:0xf bank_mask:0xf
    s_nop 1
    v_mfma_f32_16x16x32_bf16 v[56:59], v[28:31], v[124:127], v[56:59]
B1_gemv_done:
    v_lshlrev_b32 v48, 5, v3
    v_lshl_add_u32 v48, v2, 4, v48
    s_lshl_b32 s31, s24, 10
    v_add_u32 v49, s31, v48
    s_mov_b32 exec_lo, -1
    s_mov_b32 exec_hi, 0
    ds_write_b128 v49, v[24:27] offset:0
    s_nop 0
    ds_write_b128 v49, v[56:59] offset:512
    s_mov_b64 exec, -1
    s_waitcnt lgkmcnt(0)
    s_barrier
    s_mov_b32 exec_lo, -1
    s_mov_b32 exec_hi, 0
    ds_read_b128 v[192:195], v48 offset:0
    ds_read_b128 v[196:199], v48 offset:1024
    ds_read_b128 v[200:203], v48 offset:2048
    ds_read_b128 v[204:207], v48 offset:3072
    ds_read_b128 v[208:211], v48 offset:4096
    ds_read_b128 v[212:215], v48 offset:5120
    ds_read_b128 v[216:219], v48 offset:6144
    ds_read_b128 v[220:223], v48 offset:7168
    s_waitcnt lgkmcnt(0)
    v_add_f32 v192, v192, v196
    v_add_f32 v193, v193, v197
    v_add_f32 v194, v194, v198
    v_add_f32 v195, v195, v199
    v_add_f32 v192, v192, v200
    v_add_f32 v193, v193, v201
    v_add_f32 v194, v194, v202
    v_add_f32 v195, v195, v203
    v_add_f32 v192, v192, v204
    v_add_f32 v193, v193, v205
    v_add_f32 v194, v194, v206
    v_add_f32 v195, v195, v207
    v_add_f32 v192, v192, v208
    v_add_f32 v193, v193, v209
    v_add_f32 v194, v194, v210
    v_add_f32 v195, v195, v211
    v_add_f32 v192, v192, v212
    v_add_f32 v193, v193, v213
    v_add_f32 v194, v194, v214
    v_add_f32 v195, v195, v215
    v_add_f32 v192, v192, v216
    v_add_f32 v193, v193, v217
    v_add_f32 v194, v194, v218
    v_add_f32 v195, v195, v219
    v_add_f32 v192, v192, v220
    v_add_f32 v193, v193, v221
    v_add_f32 v194, v194, v222
    v_add_f32 v195, v195, v223
    v_cvt_pk_bf16_f32 v192, v192, v193
    v_cvt_pk_bf16_f32 v193, v194, v195
    v_lshrrev_b32 v50, 1, v48
    s_lshl_b32 s31, s24, 9
    v_add_u32 v50, s31, v50
    ds_write_b64 v50, v[192:193] offset:8192
    ds_read_b128 v[192:195], v48 offset:512
    ds_read_b128 v[196:199], v48 offset:1536
    ds_read_b128 v[200:203], v48 offset:2560
    ds_read_b128 v[204:207], v48 offset:3584
    ds_read_b128 v[208:211], v48 offset:4608
    ds_read_b128 v[212:215], v48 offset:5632
    ds_read_b128 v[216:219], v48 offset:6656
    ds_read_b128 v[220:223], v48 offset:7680
    s_waitcnt lgkmcnt(0)
    v_add_f32 v192, v192, v196
    v_add_f32 v193, v193, v197
    v_add_f32 v194, v194, v198
    v_add_f32 v195, v195, v199
    v_add_f32 v192, v192, v200
    v_add_f32 v193, v193, v201
    v_add_f32 v194, v194, v202
    v_add_f32 v195, v195, v203
    v_add_f32 v192, v192, v204
    v_add_f32 v193, v193, v205
    v_add_f32 v194, v194, v206
    v_add_f32 v195, v195, v207
    v_add_f32 v192, v192, v208
    v_add_f32 v193, v193, v209
    v_add_f32 v194, v194, v210
    v_add_f32 v195, v195, v211
    v_add_f32 v192, v192, v212
    v_add_f32 v193, v193, v213
    v_add_f32 v194, v194, v214
    v_add_f32 v195, v195, v215
    v_add_f32 v192, v192, v216
    v_add_f32 v193, v193, v217
    v_add_f32 v194, v194, v218
    v_add_f32 v195, v195, v219
    v_add_f32 v192, v192, v220
    v_add_f32 v193, v193, v221
    v_add_f32 v194, v194, v222
    v_add_f32 v195, v195, v223
    v_cvt_pk_bf16_f32 v192, v192, v193
    v_cvt_pk_bf16_f32 v193, v194, v195
    v_lshrrev_b32 v50, 1, v48
    s_lshl_b32 s31, s24, 9
    v_add_u32 v50, s31, v50
    ds_write_b64 v50, v[192:193] offset:8448
    s_mov_b64 exec, -1
    s_cmp_ge_u32 s24, 4
    s_cbranch_scc1 B1_end
    v_lshlrev_b32 v49, 6, v2
    v_lshl_add_u32 v49, v5, 4, v49
    s_lshl_b32 s31, s24, 9
    v_add_u32 v49, s31, v49
    s_waitcnt lgkmcnt(0)
    ds_read_b128 v[14:17], v49 offset:8192
    ds_read_b128 v[60:63], v49 offset:8448
    s_waitcnt lgkmcnt(0)
    s_waitcnt vmcnt(15)
    v_dot2_f32_bf16 v32, v128, v14, 0
    v_dot2c_f32_bf16 v32, v129, v15
    v_dot2c_f32_bf16 v32, v130, v16
    v_dot2c_f32_bf16 v32, v131, v17
    v_dot2_f32_bf16 v192, v128, v60, 0
    v_dot2c_f32_bf16 v192, v129, v61
    v_dot2c_f32_bf16 v192, v130, v62
    v_dot2c_f32_bf16 v192, v131, v63
    s_waitcnt vmcnt(14)
    v_dot2_f32_bf16 v33, v132, v14, 0
    v_dot2c_f32_bf16 v33, v133, v15
    v_dot2c_f32_bf16 v33, v134, v16
    v_dot2c_f32_bf16 v33, v135, v17
    v_dot2_f32_bf16 v193, v132, v60, 0
    v_dot2c_f32_bf16 v193, v133, v61
    v_dot2c_f32_bf16 v193, v134, v62
    v_dot2c_f32_bf16 v193, v135, v63
    s_waitcnt vmcnt(13)
    v_dot2_f32_bf16 v34, v136, v14, 0
    v_dot2c_f32_bf16 v34, v137, v15
    v_dot2c_f32_bf16 v34, v138, v16
    v_dot2c_f32_bf16 v34, v139, v17
    v_dot2_f32_bf16 v194, v136, v60, 0
    v_dot2c_f32_bf16 v194, v137, v61
    v_dot2c_f32_bf16 v194, v138, v62
    v_dot2c_f32_bf16 v194, v139, v63
    s_waitcnt vmcnt(12)
    v_dot2_f32_bf16 v35, v140, v14, 0
    v_dot2c_f32_bf16 v35, v141, v15
    v_dot2c_f32_bf16 v35, v142, v16
    v_dot2c_f32_bf16 v35, v143, v17
    v_dot2_f32_bf16 v195, v140, v60, 0
    v_dot2c_f32_bf16 v195, v141, v61
    v_dot2c_f32_bf16 v195, v142, v62
    v_dot2c_f32_bf16 v195, v143, v63
    s_waitcnt vmcnt(11)
    v_dot2_f32_bf16 v36, v144, v14, 0
    v_dot2c_f32_bf16 v36, v145, v15
    v_dot2c_f32_bf16 v36, v146, v16
    v_dot2c_f32_bf16 v36, v147, v17
    v_dot2_f32_bf16 v196, v144, v60, 0
    v_dot2c_f32_bf16 v196, v145, v61
    v_dot2c_f32_bf16 v196, v146, v62
    v_dot2c_f32_bf16 v196, v147, v63
    s_waitcnt vmcnt(10)
    v_dot2_f32_bf16 v37, v148, v14, 0
    v_dot2c_f32_bf16 v37, v149, v15
    v_dot2c_f32_bf16 v37, v150, v16
    v_dot2c_f32_bf16 v37, v151, v17
    v_dot2_f32_bf16 v197, v148, v60, 0
    v_dot2c_f32_bf16 v197, v149, v61
    v_dot2c_f32_bf16 v197, v150, v62
    v_dot2c_f32_bf16 v197, v151, v63
    s_waitcnt vmcnt(9)
    v_dot2_f32_bf16 v38, v152, v14, 0
    v_dot2c_f32_bf16 v38, v153, v15
    v_dot2c_f32_bf16 v38, v154, v16
    v_dot2c_f32_bf16 v38, v155, v17
    v_dot2_f32_bf16 v198, v152, v60, 0
    v_dot2c_f32_bf16 v198, v153, v61
    v_dot2c_f32_bf16 v198, v154, v62
    v_dot2c_f32_bf16 v198, v155, v63
    s_waitcnt vmcnt(8)
    v_dot2_f32_bf16 v39, v156, v14, 0
    v_dot2c_f32_bf16 v39, v157, v15
    v_dot2c_f32_bf16 v39, v158, v16
    v_dot2c_f32_bf16 v39, v159, v17
    v_dot2_f32_bf16 v199, v156, v60, 0
    v_dot2c_f32_bf16 v199, v157, v61
    v_dot2c_f32_bf16 v199, v158, v62
    v_dot2c_f32_bf16 v199, v159, v63
    s_waitcnt vmcnt(7)
    v_dot2_f32_bf16 v40, v160, v14, 0
    v_dot2c_f32_bf16 v40, v161, v15
    v_dot2c_f32_bf16 v40, v162, v16
    v_dot2c_f32_bf16 v40, v163, v17
    v_dot2_f32_bf16 v200, v160, v60, 0
    v_dot2c_f32_bf16 v200, v161, v61
    v_dot2c_f32_bf16 v200, v162, v62
    v_dot2c_f32_bf16 v200, v163, v63
    s_waitcnt vmcnt(6)
    v_dot2_f32_bf16 v41, v164, v14, 0
    v_dot2c_f32_bf16 v41, v165, v15
    v_dot2c_f32_bf16 v41, v166, v16
    v_dot2c_f32_bf16 v41, v167, v17
    v_dot2_f32_bf16 v201, v164, v60, 0
    v_dot2c_f32_bf16 v201, v165, v61
    v_dot2c_f32_bf16 v201, v166, v62
    v_dot2c_f32_bf16 v201, v167, v63
    s_waitcnt vmcnt(5)
    v_dot2_f32_bf16 v42, v168, v14, 0
    v_dot2c_f32_bf16 v42, v169, v15
    v_dot2c_f32_bf16 v42, v170, v16
    v_dot2c_f32_bf16 v42, v171, v17
    v_dot2_f32_bf16 v202, v168, v60, 0
    v_dot2c_f32_bf16 v202, v169, v61
    v_dot2c_f32_bf16 v202, v170, v62
    v_dot2c_f32_bf16 v202, v171, v63
    s_waitcnt vmcnt(4)
    v_dot2_f32_bf16 v43, v172, v14, 0
    v_dot2c_f32_bf16 v43, v173, v15
    v_dot2c_f32_bf16 v43, v174, v16
    v_dot2c_f32_bf16 v43, v175, v17
    v_dot2_f32_bf16 v203, v172, v60, 0
    v_dot2c_f32_bf16 v203, v173, v61
    v_dot2c_f32_bf16 v203, v174, v62
    v_dot2c_f32_bf16 v203, v175, v63
    s_waitcnt vmcnt(3)
    v_dot2_f32_bf16 v44, v176, v14, 0
    v_dot2c_f32_bf16 v44, v177, v15
    v_dot2c_f32_bf16 v44, v178, v16
    v_dot2c_f32_bf16 v44, v179, v17
    v_dot2_f32_bf16 v204, v176, v60, 0
    v_dot2c_f32_bf16 v204, v177, v61
    v_dot2c_f32_bf16 v204, v178, v62
    v_dot2c_f32_bf16 v204, v179, v63
    s_waitcnt vmcnt(2)
    v_dot2_f32_bf16 v45, v180, v14, 0
    v_dot2c_f32_bf16 v45, v181, v15
    v_dot2c_f32_bf16 v45, v182, v16
    v_dot2c_f32_bf16 v45, v183, v17
    v_dot2_f32_bf16 v205, v180, v60, 0
    v_dot2c_f32_bf16 v205, v181, v61
    v_dot2c_f32_bf16 v205, v182, v62
    v_dot2c_f32_bf16 v205, v183, v63
    s_waitcnt vmcnt(1)
    v_dot2_f32_bf16 v46, v184, v14, 0
    v_dot2c_f32_bf16 v46, v185, v15
    v_dot2c_f32_bf16 v46, v186, v16
    v_dot2c_f32_bf16 v46, v187, v17
    v_dot2_f32_bf16 v206, v184, v60, 0
    v_dot2c_f32_bf16 v206, v185, v61
    v_dot2c_f32_bf16 v206, v186, v62
    v_dot2c_f32_bf16 v206, v187, v63
    s_waitcnt vmcnt(0)
    v_dot2_f32_bf16 v47, v188, v14, 0
    v_dot2c_f32_bf16 v47, v189, v15
    v_dot2c_f32_bf16 v47, v190, v16
    v_dot2c_f32_bf16 v47, v191, v17
    v_dot2_f32_bf16 v207, v188, v60, 0
    v_dot2c_f32_bf16 v207, v189, v61
    v_dot2c_f32_bf16 v207, v190, v62
    v_dot2c_f32_bf16 v207, v191, v63
    v_permlane32_swap_b32 v32, v40
    v_add_f32 v32, v32, v40
    v_permlane32_swap_b32 v33, v41
    v_add_f32 v33, v33, v41
    v_permlane32_swap_b32 v34, v42
    v_add_f32 v34, v34, v42
    v_permlane32_swap_b32 v35, v43
    v_add_f32 v35, v35, v43
    v_permlane32_swap_b32 v36, v44
    v_add_f32 v36, v36, v44
    v_permlane32_swap_b32 v37, v45
    v_add_f32 v37, v37, v45
    v_permlane32_swap_b32 v38, v46
    v_add_f32 v38, v38, v46
    v_permlane32_swap_b32 v39, v47
    v_add_f32 v39, v39, v47
    v_permlane16_swap_b32 v32, v36
    v_add_f32 v32, v32, v36
    v_permlane16_swap_b32 v33, v37
    v_add_f32 v33, v33, v37
    v_permlane16_swap_b32 v34, v38
    v_add_f32 v34, v34, v38
    v_permlane16_swap_b32 v35, v39
    v_add_f32 v35, v35, v39
    v_cndmask_b32 v48, v32, v34, s[32:33]
    v_cndmask_b32 v49, v34, v32, s[32:33]
    s_nop 1
    v_add_f32_dpp v32, v49, v48 quad_perm:[2,3,0,1] row_mask:0xf bank_mask:0xf
    v_cndmask_b32 v48, v33, v35, s[32:33]
    v_cndmask_b32 v49, v35, v33, s[32:33]
    s_nop 1
    v_add_f32_dpp v33, v49, v48 quad_perm:[2,3,0,1] row_mask:0xf bank_mask:0xf
    v_cndmask_b32 v48, v32, v33, s[34:35]
    v_cndmask_b32 v49, v33, v32, s[34:35]
    s_nop 1
    v_add_f32_dpp v18, v49, v48 quad_perm:[1,0,3,2] row_mask:0xf bank_mask:0xf
    v_permlane32_swap_b32 v192, v200
    v_add_f32 v192, v192, v200
    v_permlane32_swap_b32 v193, v201
    v_add_f32 v193, v193, v201
    v_permlane32_swap_b32 v194, v202
    v_add_f32 v194, v194, v202
    v_permlane32_swap_b32 v195, v203
    v_add_f32 v195, v195, v203
    v_permlane32_swap_b32 v196, v204
    v_add_f32 v196, v196, v204
    v_permlane32_swap_b32 v197, v205
    v_add_f32 v197, v197, v205
    v_permlane32_swap_b32 v198, v206
    v_add_f32 v198, v198, v206
    v_permlane32_swap_b32 v199, v207
    v_add_f32 v199, v199, v207
    v_permlane16_swap_b32 v192, v196
    v_add_f32 v192, v192, v196
    v_permlane16_swap_b32 v193, v197
    v_add_f32 v193, v193, v197
    v_permlane16_swap_b32 v194, v198
    v_add_f32 v194, v194, v198
    v_permlane16_swap_b32 v195, v199
    v_add_f32 v195, v195, v199
    v_cndmask_b32 v48, v192, v194, s[32:33]
    v_cndmask_b32 v49, v194, v192, s[32:33]
    s_nop 1
    v_add_f32_dpp v192, v49, v48 quad_perm:[2,3,0,1] row_mask:0xf bank_mask:0xf
    v_cndmask_b32 v48, v193, v195, s[32:33]
    v_cndmask_b32 v49, v195, v193, s[32:33]
    s_nop 1
    v_add_f32_dpp v193, v49, v48 quad_perm:[2,3,0,1] row_mask:0xf bank_mask:0xf
    v_cndmask_b32 v48, v192, v193, s[34:35]
    v_cndmask_b32 v49, v193, v192, s[34:35]
    s_nop 1
    v_add_f32_dpp v19, v49, v48 quad_perm:[1,0,3,2] row_mask:0xf bank_mask:0xf
    s_mov_b32 s36, 0x3e0293ee
    v_mul_f32 v18, s36, v18
    v_mul_f32 v19, s36, v19
    v_cvt_pk_bf16_f32 v18, v18, v18
    v_cvt_pk_bf16_f32 v19, v19, v19
    s_nop 0
    v_mov_b32_dpp v48, v18 row_shl:4 row_mask:0xf bank_mask:0xf
    v_and_b32 v18, 0xffff, v18
    v_lshl_or_b32 v18, v48, 16, v18
    v_mov_b32_dpp v48, v19 row_shl:4 row_mask:0xf bank_mask:0xf
    v_and_b32 v19, 0xffff, v19
    v_lshl_or_b32 v19, v48, 16, v19
    s_lshl_b32 s31, s25, 10
    s_add_u32 s31, s31, 262144
    s_lshl_b32 s30, s24, 7
    s_add_u32 s31, s31, s30
    s_lshl_b32 s30, s27, 9
    s_add_u32 s31, s31, s30
    s_add_u32 s30, s31, 32768
    s_mov_b32 exec_lo, 0x0f0f0f0f
    s_mov_b32 exec_hi, 0x0f0f0f0f
    buffer_store_dword v18, v7, s[20:23], s31 offen sc1
    buffer_store_dword v19, v7, s[20:23], s30 offen sc1
    s_mov_b64 exec, -1
B1_end:
    s_waitcnt vmcnt(0)
    s_barrier
    s_cmp_lg_u32 s24, 0
    s_cbranch_scc1 sig_0_0
    v_mov_b32 v48, 0
    v_mov_b32 v49, 1
    s_mov_b64 exec, 1
    buffer_atomic_add v49, v48, s[56:59], 0 offen offset:0
    s_mov_b64 exec, -1
sig_0_0:
    s_load_dwordx2 s[40:41], s[0:1], 48
    s_load_dwordx2 s[48:49], s[0:1], 104
    s_lshr_b32 s25, s2, 5
    s_and_b32 s26, s2, 31
    v_and_b32 v1, 63, v0
    v_lshrrev_b32 v48, 6, v0
    v_lshrrev_b32 v2, 4, v1
    v_and_b32 v3, 15, v1
    v_readfirstlane_b32 s24, v48
    v_lshrrev_b32 v4, 2, v1
    v_and_b32 v4, 3, v4
    v_and_b32 v5, 3, v1
    v_lshrrev_b32 v48, 1, v3
    v_and_b32 v49, 1, v3
    v_mov_b32 v50, 0xffff
    v_mov_b32 v51, 0xffff0000
    v_cmp_eq_u32 vcc, 1, v49
    s_nop 1
    v_cndmask_b32 v50, v50, v51, vcc
    v_mov_b32 v51, 0
    v_cmp_eq_u32 vcc, 0, v48
    s_nop 1
    v_cndmask_b32 v10, v51, v50, vcc
    v_cmp_eq_u32 vcc, 1, v48
    s_nop 1
    v_cndmask_b32 v11, v51, v50, vcc
    v_cmp_eq_u32 vcc, 2, v48
    s_nop 1
    v_cndmask_b32 v12, v51, v50, vcc
    v_cmp_eq_u32 vcc, 3, v48
    s_nop 1
    v_cndmask_b32 v13, v51, v50, vcc
    v_and_b32 v48, 2, v1
    v_cmp_ne_u32 s[32:33], 0, v48
    v_and_b32 v48, 1, v1
    v_cmp_ne_u32 s[34:35], 0, v48
    s_waitcnt lgkmcnt(0)
    s_mov_b32 s4, s40
    s_mov_b32 s5, s41
    s_mov_b32 s6, 8388608
    s_mov_b32 s7, 0x00020000
    s_mov_b32 s20, s48
    s_mov_b32 s21, s49
    s_mov_b32 s22, 268435456
    s_mov_b32 s23, 0x00020000
    v_lshlrev_b32 v22, 4, v1
    s_lshl_b32 s28, s25, 22
    s_lshl_b32 s31, s26, 17
    s_add_u32 s28, s28, s31
    s_lshl_b32 s31, s24, 14
    s_add_u32 s28, s28, s31
    s_mov_b32 s29, s31
    v_xor_b32 v23, 0, v22
    s_mov_b32 m0, s29
    s_nop 0
    buffer_load_dwordx4 v23, s[4:7], s28 offen nt lds
    s_add_u32 s28, s28, 1024
    s_add_u32 s29, s29, 1024
    v_xor_b32 v23, 16, v22
    s_mov_b32 m0, s29
    s_nop 0
    buffer_load_dwordx4 v23, s[4:7], s28 offen nt lds
    s_add_u32 s28, s28, 1024
    s_add_u32 s29, s29, 1024
    v_xor_b32 v23, 32, v22
    s_mov_b32 m0, s29
    s_nop 0
    buffer_load_dwordx4 v23, s[4:7], s28 offen nt lds
    s_add_u32 s28, s28, 1024
    s_add_u32 s29, s29, 1024
    v_xor_b32 v23, 48, v22
    s_mov_b32 m0, s29
    s_nop 0
    buffer_load_dwordx4 v23, s[4:7], s28 offen nt lds
    s_add_u32 s28, s28, 1024
    s_add_u32 s29, s29, 1024
    v_xor_b32 v23, 64, v22
    s_mov_b32 m0, s29
    s_nop 0
    buffer_load_dwordx4 v23, s[4:7], s28 offen nt lds
    s_add_u32 s28, s28, 1024
    s_add_u32 s29, s29, 1024
    v_xor_b32 v23, 80, v22
    s_mov_b32 m0, s29
    s_nop 0
    buffer_load_dwordx4 v23, s[4:7], s28 offen nt lds
    s_add_u32 s28, s28, 1024
    s_add_u32 s29, s29, 1024
    v_xor_b32 v23, 96, v22
    s_mov_b32 m0, s29
    s_nop 0
    buffer_load_dwordx4 v23, s[4:7], s28 offen nt lds
    s_add_u32 s28, s28, 1024
    s_add_u32 s29, s29, 1024
    v_xor_b32 v23, 112, v22
    s_mov_b32 m0, s29
    s_nop 0
    buffer_load_dwordx4 v23, s[4:7], s28 offen nt lds
    s_add_u32 s28, s28, 1024
    s_add_u32 s29, s29, 1024
    v_xor_b32 v23, 128, v22
    s_mov_b32 m0, s29
    s_nop 0
    buffer_load_dwordx4 v23, s[4:7], s28 offen nt lds
    s_add_u32 s28, s28, 1024
    s_add_u32 s29, s29, 1024
    v_xor_b32 v23, 144, v22
    s_mov_b32 m0, s29
    s_nop 0
    buffer_load_dwordx4 v23, s[4:7], s28 offen nt lds
    s_add_u32 s28, s28, 1024
    s_add_u32 s29, s29, 1024
    v_xor_b32 v23, 160, v22
    s_mov_b32 m0, s29
    s_nop 0
    buffer_load_dwordx4 v23, s[4:7], s28 offen nt lds
    s_add_u32 s28, s28, 1024
    s_add_u32 s29, s29, 1024
    v_xor_b32 v23, 176, v22
    s_mov_b32 m0, s29
    s_nop 0
    buffer_load_dwordx4 v23, s[4:7], s28 offen nt lds
    s_add_u32 s28, s28, 1024
    s_add_u32 s29, s29, 1024
    v_xor_b32 v23, 192, v22
    s_mov_b32 m0, s29
    s_nop 0
    buffer_load_dwordx4 v23, s[4:7], s28 offen nt lds
    s_add_u32 s28, s28, 1024
    s_add_u32 s29, s29, 1024
    v_xor_b32 v23, 208, v22
    s_mov_b32 m0, s29
    s_nop 0
    buffer_load_dwordx4 v23, s[4:7], s28 offen nt lds
    s_add_u32 s28, s28, 1024
    s_add_u32 s29, s29, 1024
    v_xor_b32 v23, 224, v22
    s_mov_b32 m0, s29
    s_nop 0
    buffer_load_dwordx4 v23, s[4:7], s28 offen nt lds
    s_add_u32 s28, s28, 1024
    s_add_u32 s29, s29, 1024
    v_xor_b32 v23, 240, v22
    s_mov_b32 m0, s29
    s_nop 0
    buffer_load_dwordx4 v23, s[4:7], s28 offen nt lds
    s_cmp_lg_u32 s24, 0
    s_cbranch_scc1 w_0_0_done
    v_mov_b32 v48, 0
w_0_0_loop:
    buffer_load_dword v49, v48, s[56:59], 0 offen offset:0 sc1
    s_waitcnt vmcnt(0)
    v_readfirstlane_b32 s31, v49
    s_cmp_ge_u32 s31, 64
    s_cbranch_scc1 w_0_0_done
    s_sleep 2
    s_branch w_0_0_loop
w_0_0_done:
    s_barrier
    s_lshl_b32 s28, s25, 15
    s_add_u32 s28, s28, 262144
    s_lshl_b32 s31, s24, 12
    s_add_u32 s28, s28, s31
    s_add_u32 s29, s31, 131072
    s_lshl_b32 s30, s24, 6
    s_and_b32 s30, s30, 0xc0
    s_add_u32 s31, s30, 0
    v_xor_b32 v23, s31, v22
    buffer_load_dwordx4 v[64:67], v23, s[20:23], s28 offen offset:0 sc1
    s_add_u32 s31, s30, 16
    v_xor_b32 v23, s31, v22
    buffer_load_dwordx4 v[68:71], v23, s[20:23], s28 offen offset:1024 sc1
    s_add_u32 s31, s30, 32
    v_xor_b32 v23, s31, v22
    buffer_load_dwordx4 v[72:75], v23, s[20:23], s28 offen offset:2048 sc1
    s_add_u32 s31, s30, 48
    v_xor_b32 v23, s31, v22
    buffer_load_dwordx4 v[76:79], v23, s[20:23], s28 offen offset:3072 sc1
    v_add_u32 v23, s29, v22
    s_waitcnt vmcnt(0)
    ds_write_b128 v23, v[64:67] offset:0
    ds_write_b128 v23, v[68:71] offset:1024
    ds_write_b128 v23, v[72:75] offset:2048
    ds_write_b128 v23, v[76:79] offset:3072
    v_lshl_add_u32 v48, v2, 0, 0
    v_xor_b32 v48, v48, v3
    v_lshlrev_b32 v48, 4, v48
    v_lshl_add_u32 v48, v3, 10, v48
    s_lshl_b32 s31, s24, 14
    v_add_u32 v14, s31, v48
    v_add_u32 v18, 131072, v48
    v_lshl_add_u32 v48, v2, 0, 4
    v_xor_b32 v48, v48, v3
    v_lshlrev_b32 v48, 4, v48
    v_lshl_add_u32 v48, v3, 10, v48
    s_lshl_b32 s31, s24, 14
    v_add_u32 v15, s31, v48
    v_add_u32 v19, 131072, v48
    v_lshl_add_u32 v48, v2, 0, 8
    v_xor_b32 v48, v48, v3
    v_lshlrev_b32 v48, 4, v48
    v_lshl_add_u32 v48, v3, 10, v48
    s_lshl_b32 s31, s24, 14
    v_add_u32 v16, s31, v48
    v_add_u32 v20, 131072, v48
    v_lshl_add_u32 v48, v2, 0, 12
    v_xor_b32 v48, v48, v3
    v_lshlrev_b32 v48, 4, v48
    v_lshl_add_u32 v48, v3, 10, v48
    s_lshl_b32 s31, s24, 14
    v_add_u32 v17, s31, v48
    v_add_u32 v21, 131072, v48
    s_waitcnt vmcnt(0) lgkmcnt(0)
    s_barrier
    v_mov_b32 v24, 0
    v_mov_b32 v25, 0
    v_mov_b32 v26, 0
    v_mov_b32 v27, 0
    v_mov_b32 v28, 0
    v_mov_b32 v29, 0
    v_mov_b32 v30, 0
    v_mov_b32 v31, 0
    ds_read_b128 v[32:35], v14 offset:0
    ds_read_b128 v[40:43], v18 offset:0
    ds_read_b128 v[48:51], v18 offset:16384
    ds_read_b128 v[36:39], v15 offset:0
    ds_read_b128 v[44:47], v19 offset:0
    ds_read_b128 v[52:55], v19 offset:16384
    s_waitcnt lgkmcnt(3)
    v_mfma_f32_16x16x32_bf16 v[24:27], v[32:35], v[40:43], v[24:27]
    v_mfma_f32_16x16x32_bf16 v[28:31], v[32:35], v[48:51], v[28:31]
    ds_read_b128 v[32:35], v16 offset:0
    ds_read_b128 v[40:43], v20 offset:0
    ds_read_b128 v[48:51], v20 offset:16384
    s_waitcnt lgkmcnt(3)
    v_mfma_f32_16x16x32_bf16 v[24:27], v[36:39], v[44:47], v[24:27]
    v_mfma_f32_16x16x32_bf16 v[28:31], v[36:39], v[52:55], v[28:31]
    ds_read_b128 v[36:39], v17 offset:0
    ds_read_b128 v[44:47], v21 offset:0
    ds_read_b128 v[52:55], v21 offset:16384
    s_waitcnt lgkmcnt(3)
    v_mfma_f32_16x16x32_bf16 v[24:27], v[32:35], v[40:43], v[24:27]
    v_mfma_f32_16x16x32_bf16 v[28:31], v[32:35], v[48:51], v[28:31]
    ds_read_b128 v[32:35], v14 offset:256
    ds_read_b128 v[40:43], v18 offset:256
    ds_read_b128 v[48:51], v18 offset:16640
    s_waitcnt lgkmcnt(3)
    v_mfma_f32_16x16x32_bf16 v[24:27], v[36:39], v[44:47], v[24:27]
    v_mfma_f32_16x16x32_bf16 v[28:31], v[36:39], v[52:55], v[28:31]
    ds_read_b128 v[36:39], v15 offset:256
    ds_read_b128 v[44:47], v19 offset:256
    ds_read_b128 v[52:55], v19 offset:16640
    s_waitcnt lgkmcnt(3)
    v_mfma_f32_16x16x32_bf16 v[24:27], v[32:35], v[40:43], v[24:27]
    v_mfma_f32_16x16x32_bf16 v[28:31], v[32:35], v[48:51], v[28:31]
    ds_read_b128 v[32:35], v16 offset:256
    ds_read_b128 v[40:43], v20 offset:256
    ds_read_b128 v[48:51], v20 offset:16640
    s_waitcnt lgkmcnt(3)
    v_mfma_f32_16x16x32_bf16 v[24:27], v[36:39], v[44:47], v[24:27]
    v_mfma_f32_16x16x32_bf16 v[28:31], v[36:39], v[52:55], v[28:31]
    ds_read_b128 v[36:39], v17 offset:256
    ds_read_b128 v[44:47], v21 offset:256
    ds_read_b128 v[52:55], v21 offset:16640
    s_waitcnt lgkmcnt(3)
    v_mfma_f32_16x16x32_bf16 v[24:27], v[32:35], v[40:43], v[24:27]
    v_mfma_f32_16x16x32_bf16 v[28:31], v[32:35], v[48:51], v[28:31]
    ds_read_b128 v[32:35], v14 offset:512
    ds_read_b128 v[40:43], v18 offset:512
    ds_read_b128 v[48:51], v18 offset:16896
    s_waitcnt lgkmcnt(3)
    v_mfma_f32_16x16x32_bf16 v[24:27], v[36:39], v[44:47], v[24:27]
    v_mfma_f32_16x16x32_bf16 v[28:31], v[36:39], v[52:55], v[28:31]
    ds_read_b128 v[36:39], v15 offset:512
    ds_read_b128 v[44:47], v19 offset:512
    ds_read_b128 v[52:55], v19 offset:16896
    s_waitcnt lgkmcnt(3)
    v_mfma_f32_16x16x32_bf16 v[24:27], v[32:35], v[40:43], v[24:27]
    v_mfma_f32_16x16x32_bf16 v[28:31], v[32:35], v[48:51], v[28:31]
    ds_read_b128 v[32:35], v16 offset:512
    ds_read_b128 v[40:43], v20 offset:512
    ds_read_b128 v[48:51], v20 offset:16896
    s_waitcnt lgkmcnt(3)
    v_mfma_f32_16x16x32_bf16 v[24:27], v[36:39], v[44:47], v[24:27]
    v_mfma_f32_16x16x32_bf16 v[28:31], v[36:39], v[52:55], v[28:31]
    ds_read_b128 v[36:39], v17 offset:512
    ds_read_b128 v[44:47], v21 offset:512
    ds_read_b128 v[52:55], v21 offset:16896
    s_waitcnt lgkmcnt(3)
    v_mfma_f32_16x16x32_bf16 v[24:27], v[32:35], v[40:43], v[24:27]
    v_mfma_f32_16x16x32_bf16 v[28:31], v[32:35], v[48:51], v[28:31]
    ds_read_b128 v[32:35], v14 offset:768
    ds_read_b128 v[40:43], v18 offset:768
    ds_read_b128 v[48:51], v18 offset:17152
    s_waitcnt lgkmcnt(3)
    v_mfma_f32_16x16x32_bf16 v[24:27], v[36:39], v[44:47], v[24:27]
    v_mfma_f32_16x16x32_bf16 v[28:31], v[36:39], v[52:55], v[28:31]
    ds_read_b128 v[36:39], v15 offset:768
    ds_read_b128 v[44:47], v19 offset:768
    ds_read_b128 v[52:55], v19 offset:17152
    s_waitcnt lgkmcnt(3)
    v_mfma_f32_16x16x32_bf16 v[24:27], v[32:35], v[40:43], v[24:27]
    v_mfma_f32_16x16x32_bf16 v[28:31], v[32:35], v[48:51], v[28:31]
    ds_read_b128 v[32:35], v16 offset:768
    ds_read_b128 v[40:43], v20 offset:768
    ds_read_b128 v[48:51], v20 offset:17152
    s_waitcnt lgkmcnt(3)
    v_mfma_f32_16x16x32_bf16 v[24:27], v[36:39], v[44:47], v[24:27]
    v_mfma_f32_16x16x32_bf16 v[28:31], v[36:39], v[52:55], v[28:31]
    ds_read_b128 v[36:39], v17 offset:768
    ds_read_b128 v[44:47], v21 offset:768
    ds_read_b128 v[52:55], v21 offset:17152
    s_waitcnt lgkmcnt(3)
    v_mfma_f32_16x16x32_bf16 v[24:27], v[32:35], v[40:43], v[24:27]
    v_mfma_f32_16x16x32_bf16 v[28:31], v[32:35], v[48:51], v[28:31]
    s_waitcnt lgkmcnt(0)
    v_mfma_f32_16x16x32_bf16 v[24:27], v[36:39], v[44:47], v[24:27]
    v_mfma_f32_16x16x32_bf16 v[28:31], v[36:39], v[52:55], v[28:31]
    s_nop 6
    v_max3_f32 v52, v24, v25, v26
    v_max_f32 v52, v52, v27
    v_max3_f32 v53, v28, v29, v30
    v_max_f32 v53, v53, v31
    v_mov_b32 v48, v52
    v_mov_b32 v49, v52
    s_nop 1
    v_permlane16_swap_b32 v48, v49
    v_max_f32 v52, v48, v49
    v_mov_b32 v48, v52
    v_mov_b32 v49, v52
    s_nop 1
    v_permlane32_swap_b32 v48, v49
    v_max_f32 v52, v48, v49
    v_mov_b32 v48, v53
    v_mov_b32 v49, v53
    s_nop 1
    v_permlane16_swap_b32 v48, v49
    v_max_f32 v53, v48, v49
    v_mov_b32 v48, v53
    v_mov_b32 v49, v53
    s_nop 1
    v_permlane32_swap_b32 v48, v49
    v_max_f32 v53, v48, v49
    v_lshlrev_b32 v50, 5, v3
    s_lshl_b32 s31, s24, 2
    v_add_u32 v50, s31, v50
    v_add_u32 v50, 131072, v50
    s_barrier
    s_mov_b64 exec, 0xffff
    ds_write_b32 v50, v52 offset:8704
    ds_write_b32 v50, v53 offset:9216
    s_mov_b64 exec, -1
    v_lshlrev_b32 v51, 5, v3
    v_add_u32 v51, 131072, v51
    s_waitcnt lgkmcnt(0)
    s_barrier
    ds_read_b128 v[56:59], v51 offset:8704
    ds_read_b128 v[60:63], v51 offset:8720
    ds_read_b128 v[64:67], v51 offset:9216
    ds_read_b128 v[68:71], v51 offset:9232
    s_waitcnt lgkmcnt(0)
    v_max3_f32 v52, v56, v57, v58
    v_max3_f32 v52, v52, v59, v60
    v_max3_f32 v52, v52, v61, v62
    v_max_f32 v52, v52, v63
    v_max3_f32 v53, v64, v65, v66
    v_max3_f32 v53, v53, v67, v68
    v_max3_f32 v53, v53, v69, v70
    v_max_f32 v53, v53, v71
    v_sub_f32 v24, v24, v52
    v_sub_f32 v28, v28, v53
    v_sub_f32 v25, v25, v52
    v_sub_f32 v29, v29, v53
    v_sub_f32 v26, v26, v52
    v_sub_f32 v30, v30, v53
    v_sub_f32 v27, v27, v52
    v_sub_f32 v31, v31, v53
    v_exp_f32 v24, v24
    v_exp_f32 v25, v25
    v_exp_f32 v26, v26
    v_exp_f32 v27, v27
    v_exp_f32 v28, v28
    v_exp_f32 v29, v29
    v_exp_f32 v30, v30
    v_exp_f32 v31, v31
    v_cvt_pk_bf16_f32 v56, v24, v25
    v_cvt_pk_bf16_f32 v57, v26, v27
    v_cvt_pk_bf16_f32 v58, v28, v29
    v_cvt_pk_bf16_f32 v59, v30, v31
    s_lshl_b32 s31, s24, 5
    v_mov_b32 v50, 272
    v_mul_lo_u32 v50, v3, v50
    v_lshl_add_u32 v50, v2, 3, v50
    v_add_u32 v50, s31, v50
    v_add_u32 v50, 131072, v50
    ds_write_b64 v50, v[56:57] offset:0
    ds_write_b64 v50, v[58:59] offset:4352
    v_lshlrev_b32 v60, 16, v56
    v_and_b32 v61, 0xffff0000, v56
    v_lshlrev_b32 v62, 16, v57
    v_and_b32 v63, 0xffff0000, v57
    v_add_f32 v60, v60, v61
    v_add_f32 v62, v62, v63
    v_add_f32 v54, v60, v62
    v_mov_b32 v48, v54
    v_mov_b32 v49, v54
    s_nop 1
    v_permlane16_swap_b32 v48, v49
    v_add_f32 v54, v48, v49
    v_mov_b32 v48, v54
    v_mov_b32 v49, v54
    s_nop 1
    v_permlane32_swap_b32 v48, v49
    v_add_f32 v54, v48, v49
    v_lshlrev_b32 v60, 16, v58
    v_and_b32 v61, 0xffff0000, v58
    v_lshlrev_b32 v62, 16, v59
    v_and_b32 v63, 0xffff0000, v59
    v_add_f32 v60, v60, v61
    v_add_f32 v62, v62, v63
    v_add_f32 v55, v60, v62
    v_mov_b32 v48, v55
    v_mov_b32 v49, v55
    s_nop 1
    v_permlane16_swap_b32 v48, v49
    v_add_f32 v55, v48, v49
    v_mov_b32 v48, v55
    v_mov_b32 v49, v55
    s_nop 1
    v_permlane32_swap_b32 v48, v49
    v_add_f32 v55, v48, v49
    v_lshlrev_b32 v50, 5, v3
    s_lshl_b32 s31, s24, 2
    v_add_u32 v50, s31, v50
    v_add_u32 v50, 131072, v50
    s_mov_b64 exec, 0xffff
    ds_write_b32 v50, v54 offset:9728
    ds_write_b32 v50, v55 offset:10240
    s_mov_b64 exec, -1
    s_waitcnt lgkmcnt(0)
    s_barrier
    s_cmp_lg_u32 s24, 0
    s_cbranch_scc1 B2_nostat
    s_mov_b32 exec_lo, -1
    s_mov_b32 exec_hi, 0
    v_lshlrev_b32 v50, 5, v1
    v_add_u32 v50, 131072, v50
    ds_read_b128 v[56:59], v50 offset:9728
    ds_read_b128 v[60:63], v50 offset:9744
    v_cmp_gt_u32 vcc, 16, v1
    s_nop 1
    v_cndmask_b32 v64, v53, v52, vcc
    s_waitcnt lgkmcnt(0)
    v_add_f32 v56, v56, v57
    v_add_f32 v58, v58, v59
    v_add_f32 v60, v60, v61
    v_add_f32 v62, v62, v63
    v_add_f32 v56, v56, v58
    v_add_f32 v60, v60, v62
    v_add_f32 v65, v56, v60
    s_lshl_b32 s31, s2, 8
    s_add_u32 s31, s31, 327680
    v_lshlrev_b32 v50, 3, v1
    buffer_store_dwordx2 v[64:65], v50, s[20:23], s31 offen sc1
    s_mov_b64 exec, -1
B2_nostat:
    v_lshrrev_b32 v48, 2, v3
    v_and_b32 v49, 3, v3
    v_lshl_add_u32 v50, v2, 3, v48
    s_and_b32 s30, s24, 1
    s_lshl_b32 s30, s30, 3
    s_lshr_b32 s31, s24, 1
    s_lshl_b32 s31, s31, 8
    v_add_u32 v51, 0, v50
    v_and_b32 v24, 15, v51
    v_lshrrev_b32 v25, 1, v49
    v_add_u32 v25, s30, v25
    v_add_u32 v25, 0, v25
    v_xor_b32 v25, v25, v24
    v_lshlrev_b32 v25, 4, v25
    v_lshl_add_u32 v25, v51, 10, v25
    v_and_b32 v26, 1, v49
    v_lshl_add_u32 v25, v26, 3, v25
    v_add_u32 v56, s31, v25
    v_add_u32 v51, 4, v50
    v_and_b32 v24, 15, v51
    v_lshrrev_b32 v25, 1, v49
    v_add_u32 v25, s30, v25
    v_add_u32 v25, 0, v25
    v_xor_b32 v25, v25, v24
    v_lshlrev_b32 v25, 4, v25
    v_lshl_add_u32 v25, v51, 10, v25
    v_and_b32 v26, 1, v49
    v_lshl_add_u32 v25, v26, 3, v25
    v_add_u32 v57, s31, v25
    v_add_u32 v51, 0, v50
    v_and_b32 v24, 15, v51
    v_lshrrev_b32 v25, 1, v49
    v_add_u32 v25, s30, v25
    v_add_u32 v25, 2, v25
    v_xor_b32 v25, v25, v24
    v_lshlrev_b32 v25, 4, v25
    v_lshl_add_u32 v25, v51, 10, v25
    v_and_b32 v26, 1, v49
    v_lshl_add_u32 v25, v26, 3, v25
    v_add_u32 v58, s31, v25
    v_add_u32 v51, 4, v50
    v_and_b32 v24, 15, v51
    v_lshrrev_b32 v25, 1, v49
    v_add_u32 v25, s30, v25
    v_add_u32 v25, 2, v25
    v_xor_b32 v25, v25, v24
    v_lshlrev_b32 v25, 4, v25
    v_lshl_add_u32 v25, v51, 10, v25
    v_and_b32 v26, 1, v49
    v_lshl_add_u32 v25, v26, 3, v25
    v_add_u32 v59, s31, v25
    v_add_u32 v51, 0, v50
    v_and_b32 v24, 15, v51
    v_lshrrev_b32 v25, 1, v49
    v_add_u32 v25, s30, v25
    v_add_u32 v25, 4, v25
    v_xor_b32 v25, v25, v24
    v_lshlrev_b32 v25, 4, v25
    v_lshl_add_u32 v25, v51, 10, v25
    v_and_b32 v26, 1, v49
    v_lshl_add_u32 v25, v26, 3, v25
    v_add_u32 v60, s31, v25
    v_add_u32 v51, 4, v50
    v_and_b32 v24, 15, v51
    v_lshrrev_b32 v25, 1, v49
    v_add_u32 v25, s30, v25
    v_add_u32 v25, 4, v25
    v_xor_b32 v25, v25, v24
    v_lshlrev_b32 v25, 4, v25
    v_lshl_add_u32 v25, v51, 10, v25
    v_and_b32 v26, 1, v49
    v_lshl_add_u32 v25, v26, 3, v25
    v_add_u32 v61, s31, v25
    v_add_u32 v51, 0, v50
    v_and_b32 v24, 15, v51
    v_lshrrev_b32 v25, 1, v49
    v_add_u32 v25, s30, v25
    v_add_u32 v25, 6, v25
    v_xor_b32 v25, v25, v24
    v_lshlrev_b32 v25, 4, v25
    v_lshl_add_u32 v25, v51, 10, v25
    v_and_b32 v26, 1, v49
    v_lshl_add_u32 v25, v26, 3, v25
    v_add_u32 v62, s31, v25
    v_add_u32 v51, 4, v50
    v_and_b32 v24, 15, v51
    v_lshrrev_b32 v25, 1, v49
    v_add_u32 v25, s30, v25
    v_add_u32 v25, 6, v25
    v_xor_b32 v25, v25, v24
    v_lshlrev_b32 v25, 4, v25
    v_lshl_add_u32 v25, v51, 10, v25
    v_and_b32 v26, 1, v49
    v_lshl_add_u32 v25, v26, 3, v25
    v_add_u32 v63, s31, v25
    v_mov_b32 v54, 272
    v_mul_lo_u32 v54, v3, v54
    v_lshl_add_u32 v54, v2, 4, v54
    v_add_u32 v54, 131072, v54
    v_mov_b32 v64, 0
    v_mov_b32 v65, 0
    v_mov_b32 v66, 0
    v_mov_b32 v67, 0
    v_mov_b32 v68, 0
    v_mov_b32 v69, 0
    v_mov_b32 v70, 0
    v_mov_b32 v71, 0
    v_mov_b32 v72, 0
    v_mov_b32 v73, 0
    v_mov_b32 v74, 0
    v_mov_b32 v75, 0
    v_mov_b32 v76, 0
    v_mov_b32 v77, 0
    v_mov_b32 v78, 0
    v_mov_b32 v79, 0
    v_mov_b32 v80, 0
    v_mov_b32 v81, 0
    v_mov_b32 v82, 0
    v_mov_b32 v83, 0
    v_mov_b32 v84, 0
    v_mov_b32 v85, 0
    v_mov_b32 v86, 0
    v_mov_b32 v87, 0
    v_mov_b32 v88, 0
    v_mov_b32 v89, 0
    v_mov_b32 v90, 0
    v_mov_b32 v91, 0
    v_mov_b32 v92, 0
    v_mov_b32 v93, 0
    v_mov_b32 v94, 0
    v_mov_b32 v95, 0
    ds_read_b128 v[96:99], v54 offset:0
    ds_read_b128 v[100:103], v54 offset:4352
    ds_read_b64_tr_b16 v[112:113], v56 offset:0
    ds_read_b64_tr_b16 v[114:115], v57 offset:0
    ds_read_b64_tr_b16 v[116:117], v58 offset:0
    ds_read_b64_tr_b16 v[118:119], v59 offset:0
    ds_read_b64_tr_b16 v[120:121], v60 offset:0
    ds_read_b64_tr_b16 v[122:123], v61 offset:0
    ds_read_b64_tr_b16 v[124:125], v62 offset:0
    ds_read_b64_tr_b16 v[126:127], v63 offset:0
    s_waitcnt lgkmcnt(0)
    v_mfma_f32_16x16x32_bf16 v[64:67], v[112:115], v[96:99], v[64:67]
    v_mfma_f32_16x16x32_bf16 v[68:71], v[116:119], v[96:99], v[68:71]
    v_mfma_f32_16x16x32_bf16 v[72:75], v[120:123], v[96:99], v[72:75]
    v_mfma_f32_16x16x32_bf16 v[76:79], v[124:127], v[96:99], v[76:79]
    v_mfma_f32_16x16x32_bf16 v[80:83], v[112:115], v[100:103], v[80:83]
    v_mfma_f32_16x16x32_bf16 v[84:87], v[116:119], v[100:103], v[84:87]
    v_mfma_f32_16x16x32_bf16 v[88:91], v[120:123], v[100:103], v[88:91]
    v_mfma_f32_16x16x32_bf16 v[92:95], v[124:127], v[100:103], v[92:95]
    ds_read_b128 v[96:99], v54 offset:64
    ds_read_b128 v[100:103], v54 offset:4416
    ds_read_b64_tr_b16 v[112:113], v56 offset:32768
    ds_read_b64_tr_b16 v[114:115], v57 offset:32768
    ds_read_b64_tr_b16 v[116:117], v58 offset:32768
    ds_read_b64_tr_b16 v[118:119], v59 offset:32768
    ds_read_b64_tr_b16 v[120:121], v60 offset:32768
    ds_read_b64_tr_b16 v[122:123], v61 offset:32768
    ds_read_b64_tr_b16 v[124:125], v62 offset:32768
    ds_read_b64_tr_b16 v[126:127], v63 offset:32768
    s_waitcnt lgkmcnt(0)
    v_mfma_f32_16x16x32_bf16 v[64:67], v[112:115], v[96:99], v[64:67]
    v_mfma_f32_16x16x32_bf16 v[68:71], v[116:119], v[96:99], v[68:71]
    v_mfma_f32_16x16x32_bf16 v[72:75], v[120:123], v[96:99], v[72:75]
    v_mfma_f32_16x16x32_bf16 v[76:79], v[124:127], v[96:99], v[76:79]
    v_mfma_f32_16x16x32_bf16 v[80:83], v[112:115], v[100:103], v[80:83]
    v_mfma_f32_16x16x32_bf16 v[84:87], v[116:119], v[100:103], v[84:87]
    v_mfma_f32_16x16x32_bf16 v[88:91], v[120:123], v[100:103], v[88:91]
    v_mfma_f32_16x16x32_bf16 v[92:95], v[124:127], v[100:103], v[92:95]
    v_add_u32 v56, 0x10000, v56
    v_add_u32 v57, 0x10000, v57
    v_add_u32 v58, 0x10000, v58
    v_add_u32 v59, 0x10000, v59
    v_add_u32 v60, 0x10000, v60
    v_add_u32 v61, 0x10000, v61
    v_add_u32 v62, 0x10000, v62
    v_add_u32 v63, 0x10000, v63
    ds_read_b128 v[96:99], v54 offset:128
    ds_read_b128 v[100:103], v54 offset:4480
    ds_read_b64_tr_b16 v[112:113], v56 offset:0
    ds_read_b64_tr_b16 v[114:115], v57 offset:0
    ds_read_b64_tr_b16 v[116:117], v58 offset:0
    ds_read_b64_tr_b16 v[118:119], v59 offset:0
    ds_read_b64_tr_b16 v[120:121], v60 offset:0
    ds_read_b64_tr_b16 v[122:123], v61 offset:0
    ds_read_b64_tr_b16 v[124:125], v62 offset:0
    ds_read_b64_tr_b16 v[126:127], v63 offset:0
    s_waitcnt lgkmcnt(0)
    v_mfma_f32_16x16x32_bf16 v[64:67], v[112:115], v[96:99], v[64:67]
    v_mfma_f32_16x16x32_bf16 v[68:71], v[116:119], v[96:99], v[68:71]
    v_mfma_f32_16x16x32_bf16 v[72:75], v[120:123], v[96:99], v[72:75]
    v_mfma_f32_16x16x32_bf16 v[76:79], v[124:127], v[96:99], v[76:79]
    v_mfma_f32_16x16x32_bf16 v[80:83], v[112:115], v[100:103], v[80:83]
    v_mfma_f32_16x16x32_bf16 v[84:87], v[116:119], v[100:103], v[84:87]
    v_mfma_f32_16x16x32_bf16 v[88:91], v[120:123], v[100:103], v[88:91]
    v_mfma_f32_16x16x32_bf16 v[92:95], v[124:127], v[100:103], v[92:95]
    ds_read_b128 v[96:99], v54 offset:192
    ds_read_b128 v[100:103], v54 offset:4544
    ds_read_b64_tr_b16 v[112:113], v56 offset:32768
    ds_read_b64_tr_b16 v[114:115], v57 offset:32768
    ds_read_b64_tr_b16 v[116:117], v58 offset:32768
    ds_read_b64_tr_b16 v[118:119], v59 offset:32768
    ds_read_b64_tr_b16 v[120:121], v60 offset:32768
    ds_read_b64_tr_b16 v[122:123], v61 offset:32768
    ds_read_b64_tr_b16 v[124:125], v62 offset:32768
    ds_read_b64_tr_b16 v[126:127], v63 offset:32768
    s_waitcnt lgkmcnt(0)
    v_mfma_f32_16x16x32_bf16 v[64:67], v[112:115], v[96:99], v[64:67]
    v_mfma_f32_16x16x32_bf16 v[68:71], v[116:119], v[96:99], v[68:71]
    v_mfma_f32_16x16x32_bf16 v[72:75], v[120:123], v[96:99], v[72:75]
    v_mfma_f32_16x16x32_bf16 v[76:79], v[124:127], v[96:99], v[76:79]
    v_mfma_f32_16x16x32_bf16 v[80:83], v[112:115], v[100:103], v[80:83]
    v_mfma_f32_16x16x32_bf16 v[84:87], v[116:119], v[100:103], v[84:87]
    v_mfma_f32_16x16x32_bf16 v[88:91], v[120:123], v[100:103], v[88:91]
    v_mfma_f32_16x16x32_bf16 v[92:95], v[124:127], v[100:103], v[92:95]
    v_lshlrev_b32 v50, 11, v3
    v_lshl_add_u32 v50, v2, 4, v50
    s_lshl_b32 s28, s2, 16
    s_add_u32 s28, s28, 1048576
    s_lshl_b32 s31, s24, 8
    s_add_u32 s28, s28, s31
    s_add_u32 s31, s28, 0
    buffer_store_dwordx4 v[64:67], v50, s[20:23], s31 offen offset:0 sc1
    buffer_store_dwordx4 v[68:71], v50, s[20:23], s31 offen offset:64 sc1
    buffer_store_dwordx4 v[72:75], v50, s[20:23], s31 offen offset:128 sc1
    buffer_store_dwordx4 v[76:79], v50, s[20:23], s31 offen offset:192 sc1
    s_add_u32 s31, s28, 32768
    buffer_store_dwordx4 v[80:83], v50, s[20:23], s31 offen offset:0 sc1
    buffer_store_dwordx4 v[84:87], v50, s[20:23], s31 offen offset:64 sc1
    buffer_store_dwordx4 v[88:91], v50, s[20:23], s31 offen offset:128 sc1
    buffer_store_dwordx4 v[92:95], v50, s[20:23], s31 offen offset:192 sc1
    s_waitcnt vmcnt(0)
    s_barrier
    s_cmp_lg_u32 s24, 0
    s_cbranch_scc1 sig_4_1
    v_mov_b32 v48, 0
    v_mov_b32 v49, 1
    s_mov_b64 exec, 1
    buffer_atomic_add v49, v48, s[56:59], 0 offen offset:4
    s_mov_b64 exec, -1
sig_4_1:
    s_load_dwordx4 s[44:47], s[0:1], 72
    s_and_b32 s38, s2, 31
    v_lshlrev_b32 v48, 4, v3
    v_lshl_add_u32 v8, v2, 13, v48
    v_lshlrev_b32 v48, 10, v2
    v_lshl_add_u32 v9, v3, 4, v48
    s_waitcnt lgkmcnt(0)
    s_mov_b32 s96, s44
    s_mov_b32 s97, s45
    s_mov_b32 s98, 4194304
    s_mov_b32 s99, 0x00020000
    s_mov_b32 s92, s46
    s_mov_b32 s93, s47
    s_mov_b32 s94, 4194304
    s_mov_b32 s95, 0x00020000
    s_lshl_b32 s29, s24, 19
    s_lshl_b32 s31, s38, 8
    s_add_u32 s29, s29, s31
    buffer_load_dwordx4 v[128:131], v8, s[96:99], s29 offen nt
    s_add_u32 s29, s29, 32768
    buffer_load_dwordx4 v[132:135], v8, s[96:99], s29 offen nt
    s_add_u32 s29, s29, 32768
    buffer_load_dwordx4 v[136:139], v8, s[96:99], s29 offen nt
    s_add_u32 s29, s29, 32768
    buffer_load_dwordx4 v[140:143], v8, s[96:99], s29 offen nt
    s_add_u32 s29, s29, 32768
    buffer_load_dwordx4 v[144:147], v8, s[96:99], s29 offen nt
    s_add_u32 s29, s29, 32768
    buffer_load_dwordx4 v[148:151], v8, s[96:99], s29 offen nt
    s_add_u32 s29, s29, 32768
    buffer_load_dwordx4 v[152:155], v8, s[96:99], s29 offen nt
    s_add_u32 s29, s29, 32768
    buffer_load_dwordx4 v[156:159], v8, s[96:99], s29 offen nt
    s_add_u32 s29, s29, 32768
    buffer_load_dwordx4 v[160:163], v8, s[96:99], s29 offen nt
    s_add_u32 s29, s29, 32768
    buffer_load_dwordx4 v[164:167], v8, s[96:99], s29 offen nt
    s_add_u32 s29, s29, 32768
    buffer_load_dwordx4 v[168:171], v8, s[96:99], s29 offen nt
    s_add_u32 s29, s29, 32768
    buffer_load_dwordx4 v[172:175], v8, s[96:99], s29 offen nt
    s_add_u32 s29, s29, 32768
    buffer_load_dwordx4 v[176:179], v8, s[96:99], s29 offen nt
    s_add_u32 s29, s29, 32768
    buffer_load_dwordx4 v[180:183], v8, s[96:99], s29 offen nt
    s_add_u32 s29, s29, 32768
    buffer_load_dwordx4 v[184:187], v8, s[96:99], s29 offen nt
    s_add_u32 s29, s29, 32768
    buffer_load_dwordx4 v[188:191], v8, s[96:99], s29 offen nt
    s_lshl_b32 s37, s38, 17
    s_lshl_b32 s31, s24, 14
    s_add_u32 s37, s37, s31
    buffer_load_dwordx4 v[192:195], v9, s[92:95], s37 offen offset:0 nt
    buffer_load_dwordx4 v[196:199], v9, s[92:95], s37 offen offset:256 nt
    buffer_load_dwordx4 v[200:203], v9, s[92:95], s37 offen offset:512 nt
    buffer_load_dwordx4 v[204:207], v9, s[92:95], s37 offen offset:768 nt
    s_add_u32 s37, s37, 4096
    buffer_load_dwordx4 v[208:211], v9, s[92:95], s37 offen offset:0 nt
    buffer_load_dwordx4 v[212:215], v9, s[92:95], s37 offen offset:256 nt
    buffer_load_dwordx4 v[216:219], v9, s[92:95], s37 offen offset:512 nt
    buffer_load_dwordx4 v[220:223], v9, s[92:95], s37 offen offset:768 nt
    s_add_u32 s37, s37, 4096
    buffer_load_dwordx4 v[224:227], v9, s[92:95], s37 offen offset:0 nt
    buffer_load_dwordx4 v[228:231], v9, s[92:95], s37 offen offset:256 nt
    buffer_load_dwordx4 v[232:235], v9, s[92:95], s37 offen offset:512 nt
    buffer_load_dwordx4 v[236:239], v9, s[92:95], s37 offen offset:768 nt
    s_add_u32 s37, s37, 4096
    buffer_load_dwordx4 v[240:243], v9, s[92:95], s37 offen offset:0 nt
    buffer_load_dwordx4 v[244:247], v9, s[92:95], s37 offen offset:256 nt
    buffer_load_dwordx4 v[248:251], v9, s[92:95], s37 offen offset:512 nt
    buffer_load_dwordx4 v[252:255], v9, s[92:95], s37 offen offset:768 nt
    s_cmp_lg_u32 s24, 0
    s_cbranch_scc1 w_4_1_done
    v_mov_b32 v48, 0
w_4_1_loop:
    buffer_load_dword v49, v48, s[56:59], 0 offen offset:4 sc1
    s_waitcnt vmcnt(0)
    v_readfirstlane_b32 s31, v49
    s_cmp_ge_u32 s31, 64
    s_cbranch_scc1 w_4_1_done
    s_sleep 2
    s_branch w_4_1_loop
w_4_1_done:
    s_barrier
    s_and_b32 s25, s2, 31
    s_lshr_b32 s26, s2, 5
    v_and_b32 v48, 31, v1
    v_lshlrev_b32 v48, 8, v48
    s_lshl_b32 s28, s26, 13
    s_lshl_b32 s31, s25, 3
    s_add_u32 s28, s28, s31
    s_add_u32 s28, s28, 327680
    buffer_load_dwordx2 v[54:55], v48, s[20:23], s28 offen sc1
    v_lshlrev_b32 v49, 2, v1
    s_lshl_b32 s28, s26, 21
    s_add_u32 s28, s28, 1048576
    s_lshl_b32 s31, s25, 11
    s_add_u32 s28, s28, s31
    s_lshl_b32 s31, s24, 8
    s_add_u32 s28, s28, s31
    buffer_load_dword v64, v49, s[20:23], s28 offen sc1
    s_add_u32 s28, s28, 65536
    buffer_load_dword v65, v49, s[20:23], s28 offen sc1
    s_add_u32 s28, s28, 65536
    buffer_load_dword v66, v49, s[20:23], s28 offen sc1
    s_add_u32 s28, s28, 65536
    buffer_load_dword v67, v49, s[20:23], s28 offen sc1
    s_add_u32 s28, s28, 65536
    buffer_load_dword v68, v49, s[20:23], s28 offen sc1
    s_add_u32 s28, s28, 65536
    buffer_load_dword v69, v49, s[20:23], s28 offen sc1
    s_add_u32 s28, s28, 65536
    buffer_load_dword v70, v49, s[20:23], s28 offen sc1
    s_add_u32 s28, s28, 65536
    buffer_load_dword v71, v49, s[20:23], s28 offen sc1
    s_add_u32 s28, s28, 65536
    buffer_load_dword v72, v49, s[20:23], s28 offen sc1
    s_add_u32 s28, s28, 65536
    buffer_load_dword v73, v49, s[20:23], s28 offen sc1
    s_add_u32 s28, s28, 65536
    buffer_load_dword v74, v49, s[20:23], s28 offen sc1
    s_add_u32 s28, s28, 65536
    buffer_load_dword v75, v49, s[20:23], s28 offen sc1
    s_add_u32 s28, s28, 65536
    buffer_load_dword v76, v49, s[20:23], s28 offen sc1
    s_add_u32 s28, s28, 65536
    buffer_load_dword v77, v49, s[20:23], s28 offen sc1
    s_add_u32 s28, s28, 65536
    buffer_load_dword v78, v49, s[20:23], s28 offen sc1
    s_add_u32 s28, s28, 65536
    buffer_load_dword v79, v49, s[20:23], s28 offen sc1
    s_add_u32 s28, s28, 65536
    buffer_load_dword v80, v49, s[20:23], s28 offen sc1
    s_add_u32 s28, s28, 65536
    buffer_load_dword v81, v49, s[20:23], s28 offen sc1
    s_add_u32 s28, s28, 65536
    buffer_load_dword v82, v49, s[20:23], s28 offen sc1
    s_add_u32 s28, s28, 65536
    buffer_load_dword v83, v49, s[20:23], s28 offen sc1
    s_add_u32 s28, s28, 65536
    buffer_load_dword v84, v49, s[20:23], s28 offen sc1
    s_add_u32 s28, s28, 65536
    buffer_load_dword v85, v49, s[20:23], s28 offen sc1
    s_add_u32 s28, s28, 65536
    buffer_load_dword v86, v49, s[20:23], s28 offen sc1
    s_add_u32 s28, s28, 65536
    buffer_load_dword v87, v49, s[20:23], s28 offen sc1
    s_add_u32 s28, s28, 65536
    buffer_load_dword v88, v49, s[20:23], s28 offen sc1
    s_add_u32 s28, s28, 65536
    buffer_load_dword v89, v49, s[20:23], s28 offen sc1
    s_add_u32 s28, s28, 65536
    buffer_load_dword v90, v49, s[20:23], s28 offen sc1
    s_add_u32 s28, s28, 65536
    buffer_load_dword v91, v49, s[20:23], s28 offen sc1
    s_add_u32 s28, s28, 65536
    buffer_load_dword v92, v49, s[20:23], s28 offen sc1
    s_add_u32 s28, s28, 65536
    buffer_load_dword v93, v49, s[20:23], s28 offen sc1
    s_add_u32 s28, s28, 65536
    buffer_load_dword v94, v49, s[20:23], s28 offen sc1
    s_add_u32 s28, s28, 65536
    buffer_load_dword v95, v49, s[20:23], s28 offen sc1
    s_waitcnt vmcnt(32)
    v_mov_b32 v56, v54
    s_nop 1
    v_max_f32_dpp v56, v56, v56 row_ror:8 row_mask:0xf bank_mask:0xf
    s_nop 1
    v_max_f32_dpp v56, v56, v56 row_ror:4 row_mask:0xf bank_mask:0xf
    s_nop 1
    v_max_f32_dpp v56, v56, v56 row_ror:2 row_mask:0xf bank_mask:0xf
    s_nop 1
    v_max_f32_dpp v56, v56, v56 row_ror:1 row_mask:0xf bank_mask:0xf
    v_mov_b32 v48, v56
    v_mov_b32 v49, v56
    s_nop 1
    v_permlane16_swap_b32 v48, v49
    v_max_f32 v56, v48, v49
    v_mov_b32 v48, v56
    v_mov_b32 v49, v56
    s_nop 1
    v_permlane32_swap_b32 v48, v49
    v_max_f32 v56, v48, v49
    v_sub_f32 v54, v54, v56
    v_exp_f32 v54, v54
    v_cmp_gt_u32 vcc, 32, v1
    v_mul_f32 v55, v54, v55
    v_mov_b32 v57, 0
    v_cndmask_b32 v55, v57, v55, vcc
    s_nop 1
    v_add_f32_dpp v55, v55, v55 row_ror:8 row_mask:0xf bank_mask:0xf
    s_nop 1
    v_add_f32_dpp v55, v55, v55 row_ror:4 row_mask:0xf bank_mask:0xf
    s_nop 1
    v_add_f32_dpp v55, v55, v55 row_ror:2 row_mask:0xf bank_mask:0xf
    s_nop 1
    v_add_f32_dpp v55, v55, v55 row_ror:1 row_mask:0xf bank_mask:0xf
    v_mov_b32 v48, v55
    v_mov_b32 v49, v55
    s_nop 1
    v_permlane16_swap_b32 v48, v49
    v_add_f32 v55, v48, v49
    v_mov_b32 v48, v55
    v_mov_b32 v49, v55
    s_nop 1
    v_permlane32_swap_b32 v48, v49
    v_add_f32 v55, v48, v49
    v_rcp_f32 v55, v55
    s_nop 0
    v_mul_f32 v54, v54, v55
    s_nop 0
    v_readlane_b32 s64, v54, 0
    v_readlane_b32 s65, v54, 1
    v_readlane_b32 s66, v54, 2
    v_readlane_b32 s67, v54, 3
    v_readlane_b32 s68, v54, 4
    v_readlane_b32 s69, v54, 5
    v_readlane_b32 s70, v54, 6
    v_readlane_b32 s71, v54, 7
    v_readlane_b32 s72, v54, 8
    v_readlane_b32 s73, v54, 9
    v_readlane_b32 s74, v54, 10
    v_readlane_b32 s75, v54, 11
    v_readlane_b32 s76, v54, 12
    v_readlane_b32 s77, v54, 13
    v_readlane_b32 s78, v54, 14
    v_readlane_b32 s79, v54, 15
    v_readlane_b32 s80, v54, 16
    v_readlane_b32 s81, v54, 17
    v_readlane_b32 s82, v54, 18
    v_readlane_b32 s83, v54, 19
    v_readlane_b32 s84, v54, 20
    v_readlane_b32 s85, v54, 21
    v_readlane_b32 s86, v54, 22
    v_readlane_b32 s87, v54, 23
    v_readlane_b32 s88, v54, 24
    v_readlane_b32 s89, v54, 25
    v_readlane_b32 s90, v54, 26
    v_readlane_b32 s91, v54, 27
    v_readlane_b32 s92, v54, 28
    v_readlane_b32 s93, v54, 29
    v_readlane_b32 s94, v54, 30
    v_readlane_b32 s95, v54, 31
    v_mov_b32 v58, 0
    s_waitcnt vmcnt(31)
    v_fmac_f32 v58, s64, v64
    s_waitcnt vmcnt(30)
    v_fmac_f32 v58, s65, v65
    s_waitcnt vmcnt(29)
    v_fmac_f32 v58, s66, v66
    s_waitcnt vmcnt(28)
    v_fmac_f32 v58, s67, v67
    s_waitcnt vmcnt(27)
    v_fmac_f32 v58, s68, v68
    s_waitcnt vmcnt(26)
    v_fmac_f32 v58, s69, v69
    s_waitcnt vmcnt(25)
    v_fmac_f32 v58, s70, v70
    s_waitcnt vmcnt(24)
    v_fmac_f32 v58, s71, v71
    s_waitcnt vmcnt(23)
    v_fmac_f32 v58, s72, v72
    s_waitcnt vmcnt(22)
    v_fmac_f32 v58, s73, v73
    s_waitcnt vmcnt(21)
    v_fmac_f32 v58, s74, v74
    s_waitcnt vmcnt(20)
    v_fmac_f32 v58, s75, v75
    s_waitcnt vmcnt(19)
    v_fmac_f32 v58, s76, v76
    s_waitcnt vmcnt(18)
    v_fmac_f32 v58, s77, v77
    s_waitcnt vmcnt(17)
    v_fmac_f32 v58, s78, v78
    s_waitcnt vmcnt(16)
    v_fmac_f32 v58, s79, v79
    s_waitcnt vmcnt(15)
    v_fmac_f32 v58, s80, v80
    s_waitcnt vmcnt(14)
    v_fmac_f32 v58, s81, v81
    s_waitcnt vmcnt(13)
    v_fmac_f32 v58, s82, v82
    s_waitcnt vmcnt(12)
    v_fmac_f32 v58, s83, v83
    s_waitcnt vmcnt(11)
    v_fmac_f32 v58, s84, v84
    s_waitcnt vmcnt(10)
    v_fmac_f32 v58, s85, v85
    s_waitcnt vmcnt(9)
    v_fmac_f32 v58, s86, v86
    s_waitcnt vmcnt(8)
    v_fmac_f32 v58, s87, v87
    s_waitcnt vmcnt(7)
    v_fmac_f32 v58, s88, v88
    s_waitcnt vmcnt(6)
    v_fmac_f32 v58, s89, v89
    s_waitcnt vmcnt(5)
    v_fmac_f32 v58, s90, v90
    s_waitcnt vmcnt(4)
    v_fmac_f32 v58, s91, v91
    s_waitcnt vmcnt(3)
    v_fmac_f32 v58, s92, v92
    s_waitcnt vmcnt(2)
    v_fmac_f32 v58, s93, v93
    s_waitcnt vmcnt(1)
    v_fmac_f32 v58, s94, v94
    s_waitcnt vmcnt(0)
    v_fmac_f32 v58, s95, v95
    v_cvt_pk_bf16_f32 v58, v58, v58
    v_lshlrev_b32 v48, 1, v1
    s_lshl_b32 s31, s24, 7
    v_add_u32 v48, s31, v48
    ds_write_b16 v48, v58 offset:0
    s_waitcnt lgkmcnt(0)
    s_barrier
    v_lshl_add_u32 v48, v3, 2, v2
    v_lshlrev_b32 v48, 1, v48
    v_add_u32 v48, s31, v48
    ds_read_u16 v52, v48 offset:0
    s_waitcnt lgkmcnt(0)
    v_lshl_or_b32 v52, v52, 16, v52
    v_mov_b32 v24, 0
    v_mov_b32 v25, 0
    v_mov_b32 v26, 0
    v_mov_b32 v27, 0
    s_waitcnt vmcnt(0)
    v_and_b32_dpp v28, v52, v10 row_newbcast:0 row_mask:0xf bank_mask:0xf
    v_and_b32_dpp v29, v52, v11 row_newbcast:0 row_mask:0xf bank_mask:0xf
    v_and_b32_dpp v30, v52, v12 row_newbcast:0 row_mask:0xf bank_mask:0xf
    v_and_b32_dpp v31, v52, v13 row_newbcast:0 row_mask:0xf bank_mask:0xf
    s_nop 1
    v_mfma_f32_16x16x32_bf16 v[24:27], v[28:31], v[128:131], v[24:27]
    s_waitcnt vmcnt(0)
    v_and_b32_dpp v28, v52, v10 row_newbcast:1 row_mask:0xf bank_mask:0xf
    v_and_b32_dpp v29, v52, v11 row_newbcast:1 row_mask:0xf bank_mask:0xf
    v_and_b32_dpp v30, v52, v12 row_newbcast:1 row_mask:0xf bank_mask:0xf
    v_and_b32_dpp v31, v52, v13 row_newbcast:1 row_mask:0xf bank_mask:0xf
    s_nop 1
    v_mfma_f32_16x16x32_bf16 v[24:27], v[28:31], v[132:135], v[24:27]
    s_waitcnt vmcnt(0)
    v_and_b32_dpp v28, v52, v10 row_newbcast:2 row_mask:0xf bank_mask:0xf
    v_and_b32_dpp v29, v52, v11 row_newbcast:2 row_mask:0xf bank_mask:0xf
    v_and_b32_dpp v30, v52, v12 row_newbcast:2 row_mask:0xf bank_mask:0xf
    v_and_b32_dpp v31, v52, v13 row_newbcast:2 row_mask:0xf bank_mask:0xf
    s_nop 1
    v_mfma_f32_16x16x32_bf16 v[24:27], v[28:31], v[136:139], v[24:27]
    s_waitcnt vmcnt(0)
    v_and_b32_dpp v28, v52, v10 row_newbcast:3 row_mask:0xf bank_mask:0xf
    v_and_b32_dpp v29, v52, v11 row_newbcast:3 row_mask:0xf bank_mask:0xf
    v_and_b32_dpp v30, v52, v12 row_newbcast:3 row_mask:0xf bank_mask:0xf
    v_and_b32_dpp v31, v52, v13 row_newbcast:3 row_mask:0xf bank_mask:0xf
    s_nop 1
    v_mfma_f32_16x16x32_bf16 v[24:27], v[28:31], v[140:143], v[24:27]
    s_waitcnt vmcnt(0)
    v_and_b32_dpp v28, v52, v10 row_newbcast:4 row_mask:0xf bank_mask:0xf
    v_and_b32_dpp v29, v52, v11 row_newbcast:4 row_mask:0xf bank_mask:0xf
    v_and_b32_dpp v30, v52, v12 row_newbcast:4 row_mask:0xf bank_mask:0xf
    v_and_b32_dpp v31, v52, v13 row_newbcast:4 row_mask:0xf bank_mask:0xf
    s_nop 1
    v_mfma_f32_16x16x32_bf16 v[24:27], v[28:31], v[144:147], v[24:27]
    s_waitcnt vmcnt(0)
    v_and_b32_dpp v28, v52, v10 row_newbcast:5 row_mask:0xf bank_mask:0xf
    v_and_b32_dpp v29, v52, v11 row_newbcast:5 row_mask:0xf bank_mask:0xf
    v_and_b32_dpp v30, v52, v12 row_newbcast:5 row_mask:0xf bank_mask:0xf
    v_and_b32_dpp v31, v52, v13 row_newbcast:5 row_mask:0xf bank_mask:0xf
    s_nop 1
    v_mfma_f32_16x16x32_bf16 v[24:27], v[28:31], v[148:151], v[24:27]
    s_waitcnt vmcnt(0)
    v_and_b32_dpp v28, v52, v10 row_newbcast:6 row_mask:0xf bank_mask:0xf
    v_and_b32_dpp v29, v52, v11 row_newbcast:6 row_mask:0xf bank_mask:0xf
    v_and_b32_dpp v30, v52, v12 row_newbcast:6 row_mask:0xf bank_mask:0xf
    v_and_b32_dpp v31, v52, v13 row_newbcast:6 row_mask:0xf bank_mask:0xf
    s_nop 1
    v_mfma_f32_16x16x32_bf16 v[24:27], v[28:31], v[152:155], v[24:27]
    s_waitcnt vmcnt(0)
    v_and_b32_dpp v28, v52, v10 row_newbcast:7 row_mask:0xf bank_mask:0xf
    v_and_b32_dpp v29, v52, v11 row_newbcast:7 row_mask:0xf bank_mask:0xf
    v_and_b32_dpp v30, v52, v12 row_newbcast:7 row_mask:0xf bank_mask:0xf
    v_and_b32_dpp v31, v52, v13 row_newbcast:7 row_mask:0xf bank_mask:0xf
    s_nop 1
    v_mfma_f32_16x16x32_bf16 v[24:27], v[28:31], v[156:159], v[24:27]
    s_waitcnt vmcnt(0)
    v_and_b32_dpp v28, v52, v10 row_newbcast:8 row_mask:0xf bank_mask:0xf
    v_and_b32_dpp v29, v52, v11 row_newbcast:8 row_mask:0xf bank_mask:0xf
    v_and_b32_dpp v30, v52, v12 row_newbcast:8 row_mask:0xf bank_mask:0xf
    v_and_b32_dpp v31, v52, v13 row_newbcast:8 row_mask:0xf bank_mask:0xf
    s_nop 1
    v_mfma_f32_16x16x32_bf16 v[24:27], v[28:31], v[160:163], v[24:27]
    s_waitcnt vmcnt(0)
    v_and_b32_dpp v28, v52, v10 row_newbcast:9 row_mask:0xf bank_mask:0xf
    v_and_b32_dpp v29, v52, v11 row_newbcast:9 row_mask:0xf bank_mask:0xf
    v_and_b32_dpp v30, v52, v12 row_newbcast:9 row_mask:0xf bank_mask:0xf
    v_and_b32_dpp v31, v52, v13 row_newbcast:9 row_mask:0xf bank_mask:0xf
    s_nop 1
    v_mfma_f32_16x16x32_bf16 v[24:27], v[28:31], v[164:167], v[24:27]
    s_waitcnt vmcnt(0)
    v_and_b32_dpp v28, v52, v10 row_newbcast:10 row_mask:0xf bank_mask:0xf
    v_and_b32_dpp v29, v52, v11 row_newbcast:10 row_mask:0xf bank_mask:0xf
    v_and_b32_dpp v30, v52, v12 row_newbcast:10 row_mask:0xf bank_mask:0xf
    v_and_b32_dpp v31, v52, v13 row_newbcast:10 row_mask:0xf bank_mask:0xf
    s_nop 1
    v_mfma_f32_16x16x32_bf16 v[24:27], v[28:31], v[168:171], v[24:27]
    s_waitcnt vmcnt(0)
    v_and_b32_dpp v28, v52, v10 row_newbcast:11 row_mask:0xf bank_mask:0xf
    v_and_b32_dpp v29, v52, v11 row_newbcast:11 row_mask:0xf bank_mask:0xf
    v_and_b32_dpp v30, v52, v12 row_newbcast:11 row_mask:0xf bank_mask:0xf
    v_and_b32_dpp v31, v52, v13 row_newbcast:11 row_mask:0xf bank_mask:0xf
    s_nop 1
    v_mfma_f32_16x16x32_bf16 v[24:27], v[28:31], v[172:175], v[24:27]
    s_waitcnt vmcnt(0)
    v_and_b32_dpp v28, v52, v10 row_newbcast:12 row_mask:0xf bank_mask:0xf
    v_and_b32_dpp v29, v52, v11 row_newbcast:12 row_mask:0xf bank_mask:0xf
    v_and_b32_dpp v30, v52, v12 row_newbcast:12 row_mask:0xf bank_mask:0xf
    v_and_b32_dpp v31, v52, v13 row_newbcast:12 row_mask:0xf bank_mask:0xf
    s_nop 1
    v_mfma_f32_16x16x32_bf16 v[24:27], v[28:31], v[176:179], v[24:27]
    s_waitcnt vmcnt(0)
    v_and_b32_dpp v28, v52, v10 row_newbcast:13 row_mask:0xf bank_mask:0xf
    v_and_b32_dpp v29, v52, v11 row_newbcast:13 row_mask:0xf bank_mask:0xf
    v_and_b32_dpp v30, v52, v12 row_newbcast:13 row_mask:0xf bank_mask:0xf
    v_and_b32_dpp v31, v52, v13 row_newbcast:13 row_mask:0xf bank_mask:0xf
    s_nop 1
    v_mfma_f32_16x16x32_bf16 v[24:27], v[28:31], v[180:183], v[24:27]
    s_waitcnt vmcnt(0)
    v_and_b32_dpp v28, v52, v10 row_newbcast:14 row_mask:0xf bank_mask:0xf
    v_and_b32_dpp v29, v52, v11 row_newbcast:14 row_mask:0xf bank_mask:0xf
    v_and_b32_dpp v30, v52, v12 row_newbcast:14 row_mask:0xf bank_mask:0xf
    v_and_b32_dpp v31, v52, v13 row_newbcast:14 row_mask:0xf bank_mask:0xf
    s_nop 1
    v_mfma_f32_16x16x32_bf16 v[24:27], v[28:31], v[184:187], v[24:27]
    s_waitcnt vmcnt(0)
    v_and_b32_dpp v28, v52, v10 row_newbcast:15 row_mask:0xf bank_mask:0xf
    v_and_b32_dpp v29, v52, v11 row_newbcast:15 row_mask:0xf bank_mask:0xf
    v_and_b32_dpp v30, v52, v12 row_newbcast:15 row_mask:0xf bank_mask:0xf
    v_and_b32_dpp v31, v52, v13 row_newbcast:15 row_mask:0xf bank_mask:0xf
    s_nop 1
    v_mfma_f32_16x16x32_bf16 v[24:27], v[28:31], v[188:191], v[24:27]
    s_load_dwordx2 s[44:45], s[0:1], 32
    s_lshl_b32 s37, s25, 17
    s_lshl_b32 s31, s24, 14
    s_add_u32 s37, s37, s31
    s_waitcnt lgkmcnt(0)
    s_mov_b32 s88, s44
    s_mov_b32 s89, s45
    s_mov_b32 s90, 4194304
    s_mov_b32 s91, 0x00020000
    buffer_load_dwordx4 v[128:131], v9, s[88:91], s37 offen offset:0 nt
    buffer_load_dwordx4 v[132:135], v9, s[88:91], s37 offen offset:256 nt
    buffer_load_dwordx4 v[136:139], v9, s[88:91], s37 offen offset:512 nt
    buffer_load_dwordx4 v[140:143], v9, s[88:91], s37 offen offset:768 nt
    s_add_u32 s37, s37, 4096
    buffer_load_dwordx4 v[144:147], v9, s[88:91], s37 offen offset:0 nt
    buffer_load_dwordx4 v[148:151], v9, s[88:91], s37 offen offset:256 nt
    buffer_load_dwordx4 v[152:155], v9, s[88:91], s37 offen offset:512 nt
    buffer_load_dwordx4 v[156:159], v9, s[88:91], s37 offen offset:768 nt
    s_add_u32 s37, s37, 4096
    buffer_load_dwordx4 v[160:163], v9, s[88:91], s37 offen offset:0 nt
    buffer_load_dwordx4 v[164:167], v9, s[88:91], s37 offen offset:256 nt
    buffer_load_dwordx4 v[168:171], v9, s[88:91], s37 offen offset:512 nt
    buffer_load_dwordx4 v[172:175], v9, s[88:91], s37 offen offset:768 nt
    s_add_u32 s37, s37, 4096
    buffer_load_dwordx4 v[176:179], v9, s[88:91], s37 offen offset:0 nt
    buffer_load_dwordx4 v[180:183], v9, s[88:91], s37 offen offset:256 nt
    buffer_load_dwordx4 v[184:187], v9, s[88:91], s37 offen offset:512 nt
    buffer_load_dwordx4 v[188:191], v9, s[88:91], s37 offen offset:768 nt
    v_lshlrev_b32 v48, 5, v3
    v_lshl_add_u32 v48, v2, 4, v48
    s_lshl_b32 s31, s24, 9
    v_add_u32 v49, s31, v48
    s_mov_b32 exec_lo, -1
    s_mov_b32 exec_hi, 0
    ds_write_b128 v49, v[24:27] offset:2048
    s_mov_b64 exec, -1
    s_waitcnt lgkmcnt(0)
    s_barrier
    s_mov_b32 exec_lo, -1
    s_mov_b32 exec_hi, 0
    ds_read_b128 v[64:67], v48 offset:2048
    ds_read_b128 v[68:71], v48 offset:2560
    ds_read_b128 v[72:75], v48 offset:3072
    ds_read_b128 v[76:79], v48 offset:3584
    ds_read_b128 v[80:83], v48 offset:4096
    ds_read_b128 v[84:87], v48 offset:4608
    ds_read_b128 v[88:91], v48 offset:5120
    ds_read_b128 v[92:95], v48 offset:5632
    s_waitcnt lgkmcnt(0)
    v_add_f32 v64, v64, v68
    v_add_f32 v65, v65, v69
    v_add_f32 v66, v66, v70
    v_add_f32 v67, v67, v71
    v_add_f32 v64, v64, v72
    v_add_f32 v65, v65, v73
    v_add_f32 v66, v66, v74
    v_add_f32 v67, v67, v75
    v_add_f32 v64, v64, v76
    v_add_f32 v65, v65, v77
    v_add_f32 v66, v66, v78
    v_add_f32 v67, v67, v79
    v_add_f32 v64, v64, v80
    v_add_f32 v65, v65, v81
    v_add_f32 v66, v66, v82
    v_add_f32 v67, v67, v83
    v_add_f32 v64, v64, v84
    v_add_f32 v65, v65, v85
    v_add_f32 v66, v66, v86
    v_add_f32 v67, v67, v87
    v_add_f32 v64, v64, v88
    v_add_f32 v65, v65, v89
    v_add_f32 v66, v66, v90
    v_add_f32 v67, v67, v91
    v_add_f32 v64, v64, v92
    v_add_f32 v65, v65, v93
    v_add_f32 v66, v66, v94
    v_add_f32 v67, v67, v95
    v_cvt_pk_bf16_f32 v64, v64, v65
    v_cvt_pk_bf16_f32 v65, v66, v67
    v_lshrrev_b32 v50, 1, v48
    s_lshl_b32 s31, s24, 9
    v_add_u32 v50, s31, v50
    ds_write_b64 v50, v[64:65] offset:10240
    s_mov_b64 exec, -1
    s_waitcnt lgkmcnt(0)
    v_and_b32 v48, 3, v3
    v_lshl_add_u32 v48, v48, 2, v2
    v_lshlrev_b32 v48, 1, v48
    s_lshl_b32 s31, s24, 9
    s_lshl_b32 s30, s24, 5
    s_add_u32 s31, s31, s30
    v_add_u32 v48, s31, v48
    ds_read_u16 v52, v48 offset:10240
    v_mov_b32 v64, 0
    v_mov_b32 v65, 0
    v_mov_b32 v66, 0
    v_mov_b32 v67, 0
    v_mov_b32 v68, 0
    v_mov_b32 v69, 0
    v_mov_b32 v70, 0
    v_mov_b32 v71, 0
    v_mov_b32 v72, 0
    v_mov_b32 v73, 0
    v_mov_b32 v74, 0
    v_mov_b32 v75, 0
    v_mov_b32 v76, 0
    v_mov_b32 v77, 0
    v_mov_b32 v78, 0
    v_mov_b32 v79, 0
    s_waitcnt lgkmcnt(0)
    v_lshl_or_b32 v52, v52, 16, v52
    s_nop 1
    v_and_b32_dpp v28, v52, v10 row_newbcast:0 row_mask:0xf bank_mask:0xf
    v_and_b32_dpp v29, v52, v11 row_newbcast:0 row_mask:0xf bank_mask:0xf
    v_and_b32_dpp v30, v52, v12 row_newbcast:0 row_mask:0xf bank_mask:0xf
    v_and_b32_dpp v31, v52, v13 row_newbcast:0 row_mask:0xf bank_mask:0xf
    s_nop 1
    v_mfma_f32_16x16x32_bf16 v[64:67], v[28:31], v[192:195], v[64:67]
    v_mfma_f32_16x16x32_bf16 v[68:71], v[28:31], v[196:199], v[68:71]
    v_mfma_f32_16x16x32_bf16 v[72:75], v[28:31], v[200:203], v[72:75]
    v_mfma_f32_16x16x32_bf16 v[76:79], v[28:31], v[204:207], v[76:79]
    v_and_b32_dpp v28, v52, v10 row_newbcast:1 row_mask:0xf bank_mask:0xf
    v_and_b32_dpp v29, v52, v11 row_newbcast:1 row_mask:0xf bank_mask:0xf
    v_and_b32_dpp v30, v52, v12 row_newbcast:1 row_mask:0xf bank_mask:0xf
    v_and_b32_dpp v31, v52, v13 row_newbcast:1 row_mask:0xf bank_mask:0xf
    s_nop 1
    v_mfma_f32_16x16x32_bf16 v[64:67], v[28:31], v[208:211], v[64:67]
    v_mfma_f32_16x16x32_bf16 v[68:71], v[28:31], v[212:215], v[68:71]
    v_mfma_f32_16x16x32_bf16 v[72:75], v[28:31], v[216:219], v[72:75]
    v_mfma_f32_16x16x32_bf16 v[76:79], v[28:31], v[220:223], v[76:79]
    v_and_b32_dpp v28, v52, v10 row_newbcast:2 row_mask:0xf bank_mask:0xf
    v_and_b32_dpp v29, v52, v11 row_newbcast:2 row_mask:0xf bank_mask:0xf
    v_and_b32_dpp v30, v52, v12 row_newbcast:2 row_mask:0xf bank_mask:0xf
    v_and_b32_dpp v31, v52, v13 row_newbcast:2 row_mask:0xf bank_mask:0xf
    s_nop 1
    v_mfma_f32_16x16x32_bf16 v[64:67], v[28:31], v[224:227], v[64:67]
    v_mfma_f32_16x16x32_bf16 v[68:71], v[28:31], v[228:231], v[68:71]
    v_mfma_f32_16x16x32_bf16 v[72:75], v[28:31], v[232:235], v[72:75]
    v_mfma_f32_16x16x32_bf16 v[76:79], v[28:31], v[236:239], v[76:79]
    v_and_b32_dpp v28, v52, v10 row_newbcast:3 row_mask:0xf bank_mask:0xf
    v_and_b32_dpp v29, v52, v11 row_newbcast:3 row_mask:0xf bank_mask:0xf
    v_and_b32_dpp v30, v52, v12 row_newbcast:3 row_mask:0xf bank_mask:0xf
    v_and_b32_dpp v31, v52, v13 row_newbcast:3 row_mask:0xf bank_mask:0xf
    s_nop 1
    v_mfma_f32_16x16x32_bf16 v[64:67], v[28:31], v[240:243], v[64:67]
    v_mfma_f32_16x16x32_bf16 v[68:71], v[28:31], v[244:247], v[68:71]
    v_mfma_f32_16x16x32_bf16 v[72:75], v[28:31], v[248:251], v[72:75]
    v_mfma_f32_16x16x32_bf16 v[76:79], v[28:31], v[252:255], v[76:79]
    v_lshlrev_b32 v48, 5, v3
    v_lshl_add_u32 v48, v2, 4, v48
    s_lshl_b32 s31, s24, 11
    v_add_u32 v49, s31, v48
    s_mov_b32 exec_lo, -1
    s_mov_b32 exec_hi, 0
    ds_write_b128 v49, v[64:67] offset:16384
    ds_write_b128 v49, v[68:71] offset:16896
    ds_write_b128 v49, v[72:75] offset:17408
    ds_write_b128 v49, v[76:79] offset:17920
    s_mov_b64 exec, -1
    s_waitcnt lgkmcnt(0)
    s_barrier
    v_lshlrev_b32 v48, 4, v1
    s_lshl_b32 s31, s24, 8
    v_add_u32 v49, s31, v48
    s_mov_b64 exec, 0xffff
    ds_read_b128 v[64:67], v49 offset:16384
    ds_read_b128 v[68:71], v49 offset:18432
    ds_read_b128 v[72:75], v49 offset:20480
    ds_read_b128 v[76:79], v49 offset:22528
    ds_read_b128 v[80:83], v49 offset:24576
    ds_read_b128 v[84:87], v49 offset:26624
    ds_read_b128 v[88:91], v49 offset:28672
    ds_read_b128 v[92:95], v49 offset:30720
    s_waitcnt lgkmcnt(0)
    v_add_f32 v64, v64, v68
    v_add_f32 v65, v65, v69
    v_add_f32 v66, v66, v70
    v_add_f32 v67, v67, v71
    v_add_f32 v64, v64, v72
    v_add_f32 v65, v65, v73
    v_add_f32 v66, v66, v74
    v_add_f32 v67, v67, v75
    v_add_f32 v64, v64, v76
    v_add_f32 v65, v65, v77
    v_add_f32 v66, v66, v78
    v_add_f32 v67, v67, v79
    v_add_f32 v64, v64, v80
    v_add_f32 v65, v65, v81
    v_add_f32 v66, v66, v82
    v_add_f32 v67, v67, v83
    v_add_f32 v64, v64, v84
    v_add_f32 v65, v65, v85
    v_add_f32 v66, v66, v86
    v_add_f32 v67, v67, v87
    v_add_f32 v64, v64, v88
    v_add_f32 v65, v65, v89
    v_add_f32 v66, v66, v90
    v_add_f32 v67, v67, v91
    v_add_f32 v64, v64, v92
    v_add_f32 v65, v65, v93
    v_add_f32 v66, v66, v94
    v_add_f32 v67, v67, v95
    s_lshl_b32 s30, s25, 12
    s_add_u32 s30, s30, 524288
    s_lshl_b32 s29, s26, 11
    s_add_u32 s30, s30, s29
    s_add_u32 s30, s30, s31
    buffer_store_dwordx4 v[64:67], v48, s[20:23], s30 offen sc1
    s_mov_b64 exec, -1
    s_lshl_b32 s31, s25, 2
    s_mov_b32 s63, s31
    s_cmp_lg_u32 s24, 0
    s_cbranch_scc1 wd_64_2_done
    v_mov_b32 v48, 0
wd_64_2_loop:
    buffer_load_dword v49, v48, s[56:59], s63 offen offset:64 sc1
    s_waitcnt vmcnt(0)
    v_readfirstlane_b32 s31, v49
    s_cmp_ge_u32 s31, 6
    s_cbranch_scc1 wd_64_2_done
    s_sleep 2
    s_branch wd_64_2_loop
wd_64_2_done:
    s_barrier
    v_lshlrev_b32 v48, 5, v3
    v_lshl_add_u32 v48, v2, 4, v48
    v_mov_b32 v50, 0
    s_mul_i32 s28, s2, 3072
    s_and_b32 s31, s2, 31
    s_mul_i32 s28, s31, 3072
    s_lshr_b32 s31, s2, 5
    s_mul_i32 s31, s31, 98304
    s_add_u32 s28, s28, s31
    s_add_u32 s28, s28, 0
    buffer_load_dwordx4 v[64:67], v48, s[20:23], s28 offen offset:0 sc1
    buffer_load_dwordx2 v[96:97], v50, s[20:23], s28 offen offset:512 sc1
    buffer_load_dwordx4 v[68:71], v48, s[20:23], s28 offen offset:1024 sc1
    buffer_load_dwordx2 v[98:99], v50, s[20:23], s28 offen offset:1536 sc1
    buffer_load_dwordx4 v[72:75], v48, s[20:23], s28 offen offset:2048 sc1
    buffer_load_dwordx2 v[100:101], v50, s[20:23], s28 offen offset:2560 sc1
    s_waitcnt vmcnt(0)
    v_max3_f32 v54, v96, v98, v100
    v_sub_f32 v96, v96, v54
    v_exp_f32 v96, v96
    v_sub_f32 v98, v98, v54
    v_exp_f32 v98, v98
    v_sub_f32 v100, v100, v54
    v_exp_f32 v100, v100
    v_mul_f32 v55, v96, v97
    v_fmac_f32 v55, v98, v99
    v_fmac_f32 v55, v100, v101
    v_rcp_f32 v55, v55
    s_nop 0
    v_mul_f32 v96, v96, v55
    v_mul_f32 v98, v98, v55
    v_mul_f32 v100, v100, v55
    v_mul_f32 v56, v96, v64
    v_fmac_f32 v56, v98, v68
    v_fmac_f32 v56, v100, v72
    v_mul_f32 v57, v96, v65
    v_fmac_f32 v57, v98, v69
    v_fmac_f32 v57, v100, v73
    v_mul_f32 v58, v96, v66
    v_fmac_f32 v58, v98, v70
    v_fmac_f32 v58, v100, v74
    v_mul_f32 v59, v96, v67
    v_fmac_f32 v59, v98, v71
    v_fmac_f32 v59, v100, v75
    v_cvt_pk_bf16_f32 v56, v56, v57
    v_cvt_pk_bf16_f32 v57, v58, v59
    s_lshl_b32 s31, s24, 9
    v_lshrrev_b32 v50, 1, v48
    v_add_u32 v50, s31, v50
    s_mov_b32 exec_lo, -1
    s_mov_b32 exec_hi, 0
    ds_write_b64 v50, v[56:57] offset:10240
    s_mov_b64 exec, -1
    s_waitcnt lgkmcnt(0)
    v_and_b32 v48, 3, v3
    v_lshl_add_u32 v48, v48, 2, v2
    v_lshlrev_b32 v48, 1, v48
    s_lshl_b32 s31, s24, 9
    s_lshl_b32 s30, s24, 5
    s_add_u32 s31, s31, s30
    v_add_u32 v48, s31, v48
    ds_read_u16 v52, v48 offset:10240
    v_mov_b32 v64, 0
    v_mov_b32 v65, 0
    v_mov_b32 v66, 0
    v_mov_b32 v67, 0
    v_mov_b32 v68, 0
    v_mov_b32 v69, 0
    v_mov_b32 v70, 0
    v_mov_b32 v71, 0
    v_mov_b32 v72, 0
    v_mov_b32 v73, 0
    v_mov_b32 v74, 0
    v_mov_b32 v75, 0
    v_mov_b32 v76, 0
    v_mov_b32 v77, 0
    v_mov_b32 v78, 0
    v_mov_b32 v79, 0
    s_waitcnt lgkmcnt(0)
    v_lshl_or_b32 v52, v52, 16, v52
    s_nop 1
    v_and_b32_dpp v28, v52, v10 row_newbcast:0 row_mask:0xf bank_mask:0xf
    v_and_b32_dpp v29, v52, v11 row_newbcast:0 row_mask:0xf bank_mask:0xf
    v_and_b32_dpp v30, v52, v12 row_newbcast:0 row_mask:0xf bank_mask:0xf
    v_and_b32_dpp v31, v52, v13 row_newbcast:0 row_mask:0xf bank_mask:0xf
    s_nop 1
    v_mfma_f32_16x16x32_bf16 v[64:67], v[28:31], v[128:131], v[64:67]
    v_mfma_f32_16x16x32_bf16 v[68:71], v[28:31], v[132:135], v[68:71]
    v_mfma_f32_16x16x32_bf16 v[72:75], v[28:31], v[136:139], v[72:75]
    v_mfma_f32_16x16x32_bf16 v[76:79], v[28:31], v[140:143], v[76:79]
    v_and_b32_dpp v28, v52, v10 row_newbcast:1 row_mask:0xf bank_mask:0xf
    v_and_b32_dpp v29, v52, v11 row_newbcast:1 row_mask:0xf bank_mask:0xf
    v_and_b32_dpp v30, v52, v12 row_newbcast:1 row_mask:0xf bank_mask:0xf
    v_and_b32_dpp v31, v52, v13 row_newbcast:1 row_mask:0xf bank_mask:0xf
    s_nop 1
    v_mfma_f32_16x16x32_bf16 v[64:67], v[28:31], v[144:147], v[64:67]
    v_mfma_f32_16x16x32_bf16 v[68:71], v[28:31], v[148:151], v[68:71]
    v_mfma_f32_16x16x32_bf16 v[72:75], v[28:31], v[152:155], v[72:75]
    v_mfma_f32_16x16x32_bf16 v[76:79], v[28:31], v[156:159], v[76:79]
    v_and_b32_dpp v28, v52, v10 row_newbcast:2 row_mask:0xf bank_mask:0xf
    v_and_b32_dpp v29, v52, v11 row_newbcast:2 row_mask:0xf bank_mask:0xf
    v_and_b32_dpp v30, v52, v12 row_newbcast:2 row_mask:0xf bank_mask:0xf
    v_and_b32_dpp v31, v52, v13 row_newbcast:2 row_mask:0xf bank_mask:0xf
    s_nop 1
    v_mfma_f32_16x16x32_bf16 v[64:67], v[28:31], v[160:163], v[64:67]
    v_mfma_f32_16x16x32_bf16 v[68:71], v[28:31], v[164:167], v[68:71]
    v_mfma_f32_16x16x32_bf16 v[72:75], v[28:31], v[168:171], v[72:75]
    v_mfma_f32_16x16x32_bf16 v[76:79], v[28:31], v[172:175], v[76:79]
    v_and_b32_dpp v28, v52, v10 row_newbcast:3 row_mask:0xf bank_mask:0xf
    v_and_b32_dpp v29, v52, v11 row_newbcast:3 row_mask:0xf bank_mask:0xf
    v_and_b32_dpp v30, v52, v12 row_newbcast:3 row_mask:0xf bank_mask:0xf
    v_and_b32_dpp v31, v52, v13 row_newbcast:3 row_mask:0xf bank_mask:0xf
    s_nop 1
    v_mfma_f32_16x16x32_bf16 v[64:67], v[28:31], v[176:179], v[64:67]
    v_mfma_f32_16x16x32_bf16 v[68:71], v[28:31], v[180:183], v[68:71]
    v_mfma_f32_16x16x32_bf16 v[72:75], v[28:31], v[184:187], v[72:75]
    v_mfma_f32_16x16x32_bf16 v[76:79], v[28:31], v[188:191], v[76:79]
    v_lshlrev_b32 v48, 5, v3
    v_lshl_add_u32 v48, v2, 4, v48
    s_lshl_b32 s31, s24, 11
    v_add_u32 v49, s31, v48
    s_mov_b32 exec_lo, -1
    s_mov_b32 exec_hi, 0
    ds_write_b128 v49, v[64:67] offset:16384
    ds_write_b128 v49, v[68:71] offset:16896
    ds_write_b128 v49, v[72:75] offset:17408
    ds_write_b128 v49, v[76:79] offset:17920
    s_mov_b64 exec, -1
    s_waitcnt lgkmcnt(0)
    s_barrier
    v_lshlrev_b32 v48, 4, v1
    s_lshl_b32 s31, s24, 8
    v_add_u32 v49, s31, v48
    s_mov_b64 exec, 0xffff
    ds_read_b128 v[64:67], v49 offset:16384
    ds_read_b128 v[68:71], v49 offset:18432
    ds_read_b128 v[72:75], v49 offset:20480
    ds_read_b128 v[76:79], v49 offset:22528
    ds_read_b128 v[80:83], v49 offset:24576
    ds_read_b128 v[84:87], v49 offset:26624
    ds_read_b128 v[88:91], v49 offset:28672
    ds_read_b128 v[92:95], v49 offset:30720
    s_waitcnt lgkmcnt(0)
    v_add_f32 v64, v64, v68
    v_add_f32 v65, v65, v69
    v_add_f32 v66, v66, v70
    v_add_f32 v67, v67, v71
    v_add_f32 v64, v64, v72
    v_add_f32 v65, v65, v73
    v_add_f32 v66, v66, v74
    v_add_f32 v67, v67, v75
    v_add_f32 v64, v64, v76
    v_add_f32 v65, v65, v77
    v_add_f32 v66, v66, v78
    v_add_f32 v67, v67, v79
    v_add_f32 v64, v64, v80
    v_add_f32 v65, v65, v81
    v_add_f32 v66, v66, v82
    v_add_f32 v67, v67, v83
    v_add_f32 v64, v64, v84
    v_add_f32 v65, v65, v85
    v_add_f32 v66, v66, v86
    v_add_f32 v67, v67, v87
    v_add_f32 v64, v64, v88
    v_add_f32 v65, v65, v89
    v_add_f32 v66, v66, v90
    v_add_f32 v67, v67, v91
    v_add_f32 v64, v64, v92
    v_add_f32 v65, v65, v93
    v_add_f32 v66, v66, v94
    v_add_f32 v67, v67, v95
    s_lshl_b32 s30, s25, 12
    s_add_u32 s30, s30, 393216
    s_lshl_b32 s29, s26, 11
    s_add_u32 s30, s30, s29
    s_add_u32 s30, s30, s31
    buffer_store_dwordx4 v[64:67], v48, s[20:23], s30 offen sc1
    s_mov_b64 exec, -1
    s_waitcnt vmcnt(0)
    s_barrier
    s_cmp_lg_u32 s24, 0
    s_cbranch_scc1 sig_8_2
    v_mov_b32 v48, 0
    v_mov_b32 v49, 1
    s_mov_b64 exec, 1
    buffer_atomic_add v49, v48, s[56:59], 0 offen offset:8
    s_mov_b64 exec, -1
sig_8_2:
    s_cmp_lg_u32 s24, 0
    s_cbranch_scc1 w_8_3_done
    v_mov_b32 v48, 0
w_8_3_loop:
    buffer_load_dword v49, v48, s[56:59], 0 offen offset:8 sc1
    s_waitcnt vmcnt(0)
    v_readfirstlane_b32 s31, v49
    s_cmp_ge_u32 s31, 64
    s_cbranch_scc1 w_8_3_done
    s_sleep 2
    s_branch w_8_3_loop
w_8_3_done:
    s_barrier
    s_cmp_lg_u32 s24, 0
    s_cbranch_scc1 FIN_done
    s_load_dwordx2 s[44:45], s[0:1], 88
    s_lshr_b32 s25, s2, 5
    s_lshr_b32 s26, s2, 4
    s_and_b32 s26, s26, 1
    s_and_b32 s27, s2, 15
    v_lshlrev_b32 v48, 2, v1
    s_lshl_b32 s28, s25, 17
    s_add_u32 s28, s28, 393216
    s_lshl_b32 s31, s26, 11
    s_add_u32 s28, s28, s31
    s_lshl_b32 s31, s27, 7
    s_add_u32 s28, s28, s31
    s_waitcnt lgkmcnt(0)
    s_mov_b32 s4, s44
    s_mov_b32 s5, s45
    s_mov_b32 s6, 4096
    s_mov_b32 s7, 0x00020000
    s_mov_b32 exec_lo, -1
    s_mov_b32 exec_hi, 0
    buffer_load_dword v64, v48, s[20:23], s28 offen sc1
    s_add_u32 s28, s28, 4096
    buffer_load_dword v65, v48, s[20:23], s28 offen sc1
    s_add_u32 s28, s28, 4096
    buffer_load_dword v66, v48, s[20:23], s28 offen sc1
    s_add_u32 s28, s28, 4096
    buffer_load_dword v67, v48, s[20:23], s28 offen sc1
    s_add_u32 s28, s28, 4096
    buffer_load_dword v68, v48, s[20:23], s28 offen sc1
    s_add_u32 s28, s28, 4096
    buffer_load_dword v69, v48, s[20:23], s28 offen sc1
    s_add_u32 s28, s28, 4096
    buffer_load_dword v70, v48, s[20:23], s28 offen sc1
    s_add_u32 s28, s28, 4096
    buffer_load_dword v71, v48, s[20:23], s28 offen sc1
    s_add_u32 s28, s28, 4096
    buffer_load_dword v72, v48, s[20:23], s28 offen sc1
    s_add_u32 s28, s28, 4096
    buffer_load_dword v73, v48, s[20:23], s28 offen sc1
    s_add_u32 s28, s28, 4096
    buffer_load_dword v74, v48, s[20:23], s28 offen sc1
    s_add_u32 s28, s28, 4096
    buffer_load_dword v75, v48, s[20:23], s28 offen sc1
    s_add_u32 s28, s28, 4096
    buffer_load_dword v76, v48, s[20:23], s28 offen sc1
    s_add_u32 s28, s28, 4096
    buffer_load_dword v77, v48, s[20:23], s28 offen sc1
    s_add_u32 s28, s28, 4096
    buffer_load_dword v78, v48, s[20:23], s28 offen sc1
    s_add_u32 s28, s28, 4096
    buffer_load_dword v79, v48, s[20:23], s28 offen sc1
    s_add_u32 s28, s28, 4096
    buffer_load_dword v80, v48, s[20:23], s28 offen sc1
    s_add_u32 s28, s28, 4096
    buffer_load_dword v81, v48, s[20:23], s28 offen sc1
    s_add_u32 s28, s28, 4096
    buffer_load_dword v82, v48, s[20:23], s28 offen sc1
    s_add_u32 s28, s28, 4096
    buffer_load_dword v83, v48, s[20:23], s28 offen sc1
    s_add_u32 s28, s28, 4096
    buffer_load_dword v84, v48, s[20:23], s28 offen sc1
    s_add_u32 s28, s28, 4096
    buffer_load_dword v85, v48, s[20:23], s28 offen sc1
    s_add_u32 s28, s28, 4096
    buffer_load_dword v86, v48, s[20:23], s28 offen sc1
    s_add_u32 s28, s28, 4096
    buffer_load_dword v87, v48, s[20:23], s28 offen sc1
    s_add_u32 s28, s28, 4096
    buffer_load_dword v88, v48, s[20:23], s28 offen sc1
    s_add_u32 s28, s28, 4096
    buffer_load_dword v89, v48, s[20:23], s28 offen sc1
    s_add_u32 s28, s28, 4096
    buffer_load_dword v90, v48, s[20:23], s28 offen sc1
    s_add_u32 s28, s28, 4096
    buffer_load_dword v91, v48, s[20:23], s28 offen sc1
    s_add_u32 s28, s28, 4096
    buffer_load_dword v92, v48, s[20:23], s28 offen sc1
    s_add_u32 s28, s28, 4096
    buffer_load_dword v93, v48, s[20:23], s28 offen sc1
    s_add_u32 s28, s28, 4096
    buffer_load_dword v94, v48, s[20:23], s28 offen sc1
    s_add_u32 s28, s28, 4096
    buffer_load_dword v95, v48, s[20:23], s28 offen sc1
    s_waitcnt vmcnt(30)
    v_add_f32 v64, v64, v65
    s_waitcnt vmcnt(29)
    v_add_f32 v64, v64, v66
    s_waitcnt vmcnt(28)
    v_add_f32 v64, v64, v67
    s_waitcnt vmcnt(27)
    v_add_f32 v64, v64, v68
    s_waitcnt vmcnt(26)
    v_add_f32 v64, v64, v69
    s_waitcnt vmcnt(25)
    v_add_f32 v64, v64, v70
    s_waitcnt vmcnt(24)
    v_add_f32 v64, v64, v71
    s_waitcnt vmcnt(23)
    v_add_f32 v64, v64, v72
    s_waitcnt vmcnt(22)
    v_add_f32 v64, v64, v73
    s_waitcnt vmcnt(21)
    v_add_f32 v64, v64, v74
    s_waitcnt vmcnt(20)
    v_add_f32 v64, v64, v75
    s_waitcnt vmcnt(19)
    v_add_f32 v64, v64, v76
    s_waitcnt vmcnt(18)
    v_add_f32 v64, v64, v77
    s_waitcnt vmcnt(17)
    v_add_f32 v64, v64, v78
    s_waitcnt vmcnt(16)
    v_add_f32 v64, v64, v79
    s_waitcnt vmcnt(15)
    v_add_f32 v64, v64, v80
    s_waitcnt vmcnt(14)
    v_add_f32 v64, v64, v81
    s_waitcnt vmcnt(13)
    v_add_f32 v64, v64, v82
    s_waitcnt vmcnt(12)
    v_add_f32 v64, v64, v83
    s_waitcnt vmcnt(11)
    v_add_f32 v64, v64, v84
    s_waitcnt vmcnt(10)
    v_add_f32 v64, v64, v85
    s_waitcnt vmcnt(9)
    v_add_f32 v64, v64, v86
    s_waitcnt vmcnt(8)
    v_add_f32 v64, v64, v87
    s_waitcnt vmcnt(7)
    v_add_f32 v64, v64, v88
    s_waitcnt vmcnt(6)
    v_add_f32 v64, v64, v89
    s_waitcnt vmcnt(5)
    v_add_f32 v64, v64, v90
    s_waitcnt vmcnt(4)
    v_add_f32 v64, v64, v91
    s_waitcnt vmcnt(3)
    v_add_f32 v64, v64, v92
    s_waitcnt vmcnt(2)
    v_add_f32 v64, v64, v93
    s_waitcnt vmcnt(1)
    v_add_f32 v64, v64, v94
    s_waitcnt vmcnt(0)
    v_add_f32 v64, v64, v95
    v_cvt_pk_bf16_f32 v64, v64, v64
    v_lshlrev_b32 v48, 1, v1
    s_lshl_b32 s31, s26, 11
    s_lshl_b32 s30, s25, 10
    s_add_u32 s31, s31, s30
    s_lshl_b32 s30, s27, 6
    s_add_u32 s31, s31, s30
    buffer_store_short v64, v48, s[4:7], s31 offen
    s_mov_b64 exec, -1
FIN_done:
    s_branch main_end
main_A:
    s_sub_u32 s62, s2, 64
    s_load_dwordx8 s[40:47], s[0:1], 0
    s_load_dwordx2 s[48:49], s[0:1], 104
    s_and_b32 s25, s62, 7
    s_lshr_b32 s26, s62, 3
    s_and_b32 s27, s26, 3
    s_lshl_b32 s27, s27, 3
    s_add_u32 s25, s25, s27
    s_lshr_b32 s26, s62, 5
    s_cmp_ge_u32 s26, 3
    s_cselect_b32 s27, 1, 0
    s_mul_i32 s31, s27, 3
    s_sub_u32 s31, s26, s31
    s_mov_b32 s26, s27
    s_mov_b32 s27, s31
    v_and_b32 v1, 63, v0
    v_lshrrev_b32 v48, 6, v0
    v_lshrrev_b32 v2, 4, v1
    v_and_b32 v3, 15, v1
    v_readfirstlane_b32 s24, v48
    v_lshrrev_b32 v4, 2, v1
    v_and_b32 v4, 3, v4
    v_and_b32 v5, 3, v1
    v_lshrrev_b32 v48, 1, v3
    v_and_b32 v49, 1, v3
    v_mov_b32 v50, 0xffff
    v_mov_b32 v51, 0xffff0000
    v_cmp_eq_u32 vcc, 1, v49
    s_nop 1
    v_cndmask_b32 v50, v50, v51, vcc
    v_mov_b32 v51, 0
    v_cmp_eq_u32 vcc, 0, v48
    s_nop 1
    v_cndmask_b32 v10, v51, v50, vcc
    v_cmp_eq_u32 vcc, 1, v48
    s_nop 1
    v_cndmask_b32 v11, v51, v50, vcc
    v_cmp_eq_u32 vcc, 2, v48
    s_nop 1
    v_cndmask_b32 v12, v51, v50, vcc
    v_cmp_eq_u32 vcc, 3, v48
    s_nop 1
    v_cndmask_b32 v13, v51, v50, vcc
    v_and_b32 v48, 2, v1
    v_cmp_ne_u32 s[32:33], 0, v48
    v_and_b32 v48, 1, v1
    v_cmp_ne_u32 s[34:35], 0, v48
    s_mul_i32 s52, s27, 21
    s_cmp_lg_u32 s27, 0
    s_cselect_b32 s31, 1, 0
    s_add_u32 s52, s52, s31
    s_add_u32 s52, s52, s24
    s_lshl_b32 s53, s26, 5
    s_add_u32 s53, s53, s25
    s_mul_i32 s53, s53, 3
    s_add_u32 s53, s53, s27
    s_add_u32 s31, s27, 1
    s_mul_i32 s31, s31, 21
    s_add_u32 s31, s31, 1
    s_add_u32 s30, s52, 16
    s_cmp_lt_u32 s30, s31
    s_cbranch_scc1 main_A3
    v_lshlrev_b32 v6, 8, v4
    v_lshl_add_u32 v6, v2, 6, v6
    v_lshl_add_u32 v6, v5, 4, v6
    v_lshlrev_b32 v48, 4, v3
    v_lshl_add_u32 v7, v2, 12, v48
    v_lshl_add_u32 v8, v2, 13, v48
    v_lshl_add_u32 v9, v3, 2, v2
    v_lshlrev_b32 v9, 1, v9
    s_waitcnt lgkmcnt(0)
    s_mov_b32 s4, s42
    s_mov_b32 s5, s43
    s_mov_b32 s6, 67108864
    s_mov_b32 s7, 0x00020000
    s_mov_b32 s8, s44
    s_mov_b32 s9, s45
    s_mov_b32 s10, 67108864
    s_mov_b32 s11, 0x00020000
    s_mov_b32 s12, s46
    s_mov_b32 s13, s47
    s_mov_b32 s14, 4194304
    s_mov_b32 s15, 0x00020000
    s_mov_b32 s16, s40
    s_mov_b32 s17, s41
    s_mov_b32 s18, 2048
    s_mov_b32 s19, 0x00020000
    s_mov_b32 s20, s48
    s_mov_b32 s21, s49
    s_mov_b32 s22, 268435456
    s_mov_b32 s23, 0x00020000
    s_lshl_b32 s28, s26, 5
    s_add_u32 s28, s28, s25
    s_lshl_b32 s28, s28, 20
    s_lshl_b32 s31, s52, 14
    s_add_u32 s28, s28, s31
    s_lshl_b32 s29, s24, 19
    s_lshl_b32 s31, s25, 8
    s_add_u32 s29, s29, s31
    s_lshl_b32 s30, s26, 10
    s_lshl_b32 s31, s24, 7
    s_add_u32 s30, s30, s31
    buffer_load_ushort v52, v9, s[16:19], s30 offen
    buffer_load_dwordx4 v[128:131], v8, s[12:15], s29 offen
    s_add_u32 s29, s29, 32768
    buffer_load_dwordx4 v[132:135], v8, s[12:15], s29 offen
    s_add_u32 s29, s29, 32768
    buffer_load_dwordx4 v[136:139], v8, s[12:15], s29 offen
    s_add_u32 s29, s29, 32768
    buffer_load_dwordx4 v[140:143], v8, s[12:15], s29 offen
    s_add_u32 s29, s29, 32768
    buffer_load_dwordx4 v[144:147], v8, s[12:15], s29 offen
    s_add_u32 s29, s29, 32768
    buffer_load_dwordx4 v[148:151], v8, s[12:15], s29 offen
    s_add_u32 s29, s29, 32768
    buffer_load_dwordx4 v[152:155], v8, s[12:15], s29 offen
    s_add_u32 s29, s29, 32768
    buffer_load_dwordx4 v[156:159], v8, s[12:15], s29 offen
    s_add_u32 s29, s29, 32768
    buffer_load_dwordx4 v[160:163], v8, s[12:15], s29 offen
    s_add_u32 s29, s29, 32768
    buffer_load_dwordx4 v[164:167], v8, s[12:15], s29 offen
    s_add_u32 s29, s29, 32768
    buffer_load_dwordx4 v[168:171], v8, s[12:15], s29 offen
    s_add_u32 s29, s29, 32768
    buffer_load_dwordx4 v[172:175], v8, s[12:15], s29 offen
    s_add_u32 s29, s29, 32768
    buffer_load_dwordx4 v[176:179], v8, s[12:15], s29 offen
    s_add_u32 s29, s29, 32768
    buffer_load_dwordx4 v[180:183], v8, s[12:15], s29 offen
    s_add_u32 s29, s29, 32768
    buffer_load_dwordx4 v[184:187], v8, s[12:15], s29 offen
    s_add_u32 s29, s29, 32768
    buffer_load_dwordx4 v[188:191], v8, s[12:15], s29 offen
    s_add_u32 s50, s28, 0
    buffer_load_dwordx4 v[64:67], v6, s[4:7], s50 offen offset:0 nt
    buffer_load_dwordx4 v[68:71], v6, s[4:7], s50 offen offset:1024 nt
    buffer_load_dwordx4 v[72:75], v6, s[4:7], s50 offen offset:2048 nt
    buffer_load_dwordx4 v[76:79], v6, s[4:7], s50 offen offset:3072 nt
    s_add_u32 s50, s28, 4096
    buffer_load_dwordx4 v[80:83], v6, s[4:7], s50 offen offset:0 nt
    buffer_load_dwordx4 v[84:87], v6, s[4:7], s50 offen offset:1024 nt
    buffer_load_dwordx4 v[88:91], v6, s[4:7], s50 offen offset:2048 nt
    buffer_load_dwordx4 v[92:95], v6, s[4:7], s50 offen offset:3072 nt
    s_add_u32 s50, s28, 8192
    buffer_load_dwordx4 v[96:99], v6, s[4:7], s50 offen offset:0 nt
    buffer_load_dwordx4 v[100:103], v6, s[4:7], s50 offen offset:1024 nt
    buffer_load_dwordx4 v[104:107], v6, s[4:7], s50 offen offset:2048 nt
    buffer_load_dwordx4 v[108:111], v6, s[4:7], s50 offen offset:3072 nt
    s_add_u32 s50, s28, 12288
    buffer_load_dwordx4 v[112:115], v6, s[4:7], s50 offen offset:0 nt
    buffer_load_dwordx4 v[116:119], v6, s[4:7], s50 offen offset:1024 nt
    buffer_load_dwordx4 v[120:123], v6, s[4:7], s50 offen offset:2048 nt
    buffer_load_dwordx4 v[124:127], v6, s[4:7], s50 offen offset:3072 nt
    v_mov_b32 v24, 0
    v_mov_b32 v25, 0
    v_mov_b32 v26, 0
    v_mov_b32 v27, 0
    s_waitcnt vmcnt(32)
    v_lshl_or_b32 v52, v52, 16, v52
    s_waitcnt vmcnt(31)
    s_nop 0
    v_and_b32_dpp v28, v52, v10 row_newbcast:0 row_mask:0xf bank_mask:0xf
    v_and_b32_dpp v29, v52, v11 row_newbcast:0 row_mask:0xf bank_mask:0xf
    v_and_b32_dpp v30, v52, v12 row_newbcast:0 row_mask:0xf bank_mask:0xf
    v_and_b32_dpp v31, v52, v13 row_newbcast:0 row_mask:0xf bank_mask:0xf
    s_nop 1
    v_mfma_f32_16x16x32_bf16 v[24:27], v[28:31], v[128:131], v[24:27]
    s_waitcnt vmcnt(30)
    v_and_b32_dpp v28, v52, v10 row_newbcast:1 row_mask:0xf bank_mask:0xf
    v_and_b32_dpp v29, v52, v11 row_newbcast:1 row_mask:0xf bank_mask:0xf
    v_and_b32_dpp v30, v52, v12 row_newbcast:1 row_mask:0xf bank_mask:0xf
    v_and_b32_dpp v31, v52, v13 row_newbcast:1 row_mask:0xf bank_mask:0xf
    s_nop 1
    v_mfma_f32_16x16x32_bf16 v[24:27], v[28:31], v[132:135], v[24:27]
    s_waitcnt vmcnt(29)
    v_and_b32_dpp v28, v52, v10 row_newbcast:2 row_mask:0xf bank_mask:0xf
    v_and_b32_dpp v29, v52, v11 row_newbcast:2 row_mask:0xf bank_mask:0xf
    v_and_b32_dpp v30, v52, v12 row_newbcast:2 row_mask:0xf bank_mask:0xf
    v_and_b32_dpp v31, v52, v13 row_newbcast:2 row_mask:0xf bank_mask:0xf
    s_nop 1
    v_mfma_f32_16x16x32_bf16 v[24:27], v[28:31], v[136:139], v[24:27]
    s_waitcnt vmcnt(28)
    v_and_b32_dpp v28, v52, v10 row_newbcast:3 row_mask:0xf bank_mask:0xf
    v_and_b32_dpp v29, v52, v11 row_newbcast:3 row_mask:0xf bank_mask:0xf
    v_and_b32_dpp v30, v52, v12 row_newbcast:3 row_mask:0xf bank_mask:0xf
    v_and_b32_dpp v31, v52, v13 row_newbcast:3 row_mask:0xf bank_mask:0xf
    s_nop 1
    v_mfma_f32_16x16x32_bf16 v[24:27], v[28:31], v[140:143], v[24:27]
    s_waitcnt vmcnt(27)
    v_and_b32_dpp v28, v52, v10 row_newbcast:4 row_mask:0xf bank_mask:0xf
    v_and_b32_dpp v29, v52, v11 row_newbcast:4 row_mask:0xf bank_mask:0xf
    v_and_b32_dpp v30, v52, v12 row_newbcast:4 row_mask:0xf bank_mask:0xf
    v_and_b32_dpp v31, v52, v13 row_newbcast:4 row_mask:0xf bank_mask:0xf
    s_nop 1
    v_mfma_f32_16x16x32_bf16 v[24:27], v[28:31], v[144:147], v[24:27]
    s_waitcnt vmcnt(26)
    v_and_b32_dpp v28, v52, v10 row_newbcast:5 row_mask:0xf bank_mask:0xf
    v_and_b32_dpp v29, v52, v11 row_newbcast:5 row_mask:0xf bank_mask:0xf
    v_and_b32_dpp v30, v52, v12 row_newbcast:5 row_mask:0xf bank_mask:0xf
    v_and_b32_dpp v31, v52, v13 row_newbcast:5 row_mask:0xf bank_mask:0xf
    s_nop 1
    v_mfma_f32_16x16x32_bf16 v[24:27], v[28:31], v[148:151], v[24:27]
    s_waitcnt vmcnt(25)
    v_and_b32_dpp v28, v52, v10 row_newbcast:6 row_mask:0xf bank_mask:0xf
    v_and_b32_dpp v29, v52, v11 row_newbcast:6 row_mask:0xf bank_mask:0xf
    v_and_b32_dpp v30, v52, v12 row_newbcast:6 row_mask:0xf bank_mask:0xf
    v_and_b32_dpp v31, v52, v13 row_newbcast:6 row_mask:0xf bank_mask:0xf
    s_nop 1
    v_mfma_f32_16x16x32_bf16 v[24:27], v[28:31], v[152:155], v[24:27]
    s_waitcnt vmcnt(24)
    v_and_b32_dpp v28, v52, v10 row_newbcast:7 row_mask:0xf bank_mask:0xf
    v_and_b32_dpp v29, v52, v11 row_newbcast:7 row_mask:0xf bank_mask:0xf
    v_and_b32_dpp v30, v52, v12 row_newbcast:7 row_mask:0xf bank_mask:0xf
    v_and_b32_dpp v31, v52, v13 row_newbcast:7 row_mask:0xf bank_mask:0xf
    s_nop 1
    v_mfma_f32_16x16x32_bf16 v[24:27], v[28:31], v[156:159], v[24:27]
    s_waitcnt vmcnt(23)
    v_and_b32_dpp v28, v52, v10 row_newbcast:8 row_mask:0xf bank_mask:0xf
    v_and_b32_dpp v29, v52, v11 row_newbcast:8 row_mask:0xf bank_mask:0xf
    v_and_b32_dpp v30, v52, v12 row_newbcast:8 row_mask:0xf bank_mask:0xf
    v_and_b32_dpp v31, v52, v13 row_newbcast:8 row_mask:0xf bank_mask:0xf
    s_nop 1
    v_mfma_f32_16x16x32_bf16 v[24:27], v[28:31], v[160:163], v[24:27]
    s_waitcnt vmcnt(22)
    v_and_b32_dpp v28, v52, v10 row_newbcast:9 row_mask:0xf bank_mask:0xf
    v_and_b32_dpp v29, v52, v11 row_newbcast:9 row_mask:0xf bank_mask:0xf
    v_and_b32_dpp v30, v52, v12 row_newbcast:9 row_mask:0xf bank_mask:0xf
    v_and_b32_dpp v31, v52, v13 row_newbcast:9 row_mask:0xf bank_mask:0xf
    s_nop 1
    v_mfma_f32_16x16x32_bf16 v[24:27], v[28:31], v[164:167], v[24:27]
    s_waitcnt vmcnt(21)
    v_and_b32_dpp v28, v52, v10 row_newbcast:10 row_mask:0xf bank_mask:0xf
    v_and_b32_dpp v29, v52, v11 row_newbcast:10 row_mask:0xf bank_mask:0xf
    v_and_b32_dpp v30, v52, v12 row_newbcast:10 row_mask:0xf bank_mask:0xf
    v_and_b32_dpp v31, v52, v13 row_newbcast:10 row_mask:0xf bank_mask:0xf
    s_nop 1
    v_mfma_f32_16x16x32_bf16 v[24:27], v[28:31], v[168:171], v[24:27]
    s_waitcnt vmcnt(20)
    v_and_b32_dpp v28, v52, v10 row_newbcast:11 row_mask:0xf bank_mask:0xf
    v_and_b32_dpp v29, v52, v11 row_newbcast:11 row_mask:0xf bank_mask:0xf
    v_and_b32_dpp v30, v52, v12 row_newbcast:11 row_mask:0xf bank_mask:0xf
    v_and_b32_dpp v31, v52, v13 row_newbcast:11 row_mask:0xf bank_mask:0xf
    s_nop 1
    v_mfma_f32_16x16x32_bf16 v[24:27], v[28:31], v[172:175], v[24:27]
    s_waitcnt vmcnt(19)
    v_and_b32_dpp v28, v52, v10 row_newbcast:12 row_mask:0xf bank_mask:0xf
    v_and_b32_dpp v29, v52, v11 row_newbcast:12 row_mask:0xf bank_mask:0xf
    v_and_b32_dpp v30, v52, v12 row_newbcast:12 row_mask:0xf bank_mask:0xf
    v_and_b32_dpp v31, v52, v13 row_newbcast:12 row_mask:0xf bank_mask:0xf
    s_nop 1
    v_mfma_f32_16x16x32_bf16 v[24:27], v[28:31], v[176:179], v[24:27]
    s_waitcnt vmcnt(18)
    v_and_b32_dpp v28, v52, v10 row_newbcast:13 row_mask:0xf bank_mask:0xf
    v_and_b32_dpp v29, v52, v11 row_newbcast:13 row_mask:0xf bank_mask:0xf
    v_and_b32_dpp v30, v52, v12 row_newbcast:13 row_mask:0xf bank_mask:0xf
    v_and_b32_dpp v31, v52, v13 row_newbcast:13 row_mask:0xf bank_mask:0xf
    s_nop 1
    v_mfma_f32_16x16x32_bf16 v[24:27], v[28:31], v[180:183], v[24:27]
    s_waitcnt vmcnt(17)
    v_and_b32_dpp v28, v52, v10 row_newbcast:14 row_mask:0xf bank_mask:0xf
    v_and_b32_dpp v29, v52, v11 row_newbcast:14 row_mask:0xf bank_mask:0xf
    v_and_b32_dpp v30, v52, v12 row_newbcast:14 row_mask:0xf bank_mask:0xf
    v_and_b32_dpp v31, v52, v13 row_newbcast:14 row_mask:0xf bank_mask:0xf
    s_nop 1
    v_mfma_f32_16x16x32_bf16 v[24:27], v[28:31], v[184:187], v[24:27]
    s_waitcnt vmcnt(16)
    v_and_b32_dpp v28, v52, v10 row_newbcast:15 row_mask:0xf bank_mask:0xf
    v_and_b32_dpp v29, v52, v11 row_newbcast:15 row_mask:0xf bank_mask:0xf
    v_and_b32_dpp v30, v52, v12 row_newbcast:15 row_mask:0xf bank_mask:0xf
    v_and_b32_dpp v31, v52, v13 row_newbcast:15 row_mask:0xf bank_mask:0xf
    s_nop 1
    v_mfma_f32_16x16x32_bf16 v[24:27], v[28:31], v[188:191], v[24:27]
    v_lshlrev_b32 v48, 5, v3
    v_lshl_add_u32 v48, v2, 4, v48
    s_lshl_b32 s31, s24, 9
    v_add_u32 v49, s31, v48
    s_mov_b32 exec_lo, -1
    s_mov_b32 exec_hi, 0
    s_nop 1
    ds_write_b128 v49, v[24:27] offset:0
    s_mov_b64 exec, -1
    s_waitcnt lgkmcnt(0)
    s_barrier
    s_mov_b32 exec_lo, -1
    s_mov_b32 exec_hi, 0
    ds_read_b128 v[128:131], v48 offset:0
    ds_read_b128 v[132:135], v48 offset:512
    ds_read_b128 v[136:139], v48 offset:1024
    ds_read_b128 v[140:143], v48 offset:1536
    ds_read_b128 v[144:147], v48 offset:2048
    ds_read_b128 v[148:151], v48 offset:2560
    ds_read_b128 v[152:155], v48 offset:3072
    ds_read_b128 v[156:159], v48 offset:3584
    s_waitcnt lgkmcnt(0)
    v_add_f32 v128, v128, v132
    v_add_f32 v129, v129, v133
    v_add_f32 v130, v130, v134
    v_add_f32 v131, v131, v135
    v_add_f32 v128, v128, v136
    v_add_f32 v129, v129, v137
    v_add_f32 v130, v130, v138
    v_add_f32 v131, v131, v139
    v_add_f32 v128, v128, v140
    v_add_f32 v129, v129, v141
    v_add_f32 v130, v130, v142
    v_add_f32 v131, v131, v143
    v_add_f32 v128, v128, v144
    v_add_f32 v129, v129, v145
    v_add_f32 v130, v130, v146
    v_add_f32 v131, v131, v147
    v_add_f32 v128, v128, v148
    v_add_f32 v129, v129, v149
    v_add_f32 v130, v130, v150
    v_add_f32 v131, v131, v151
    v_add_f32 v128, v128, v152
    v_add_f32 v129, v129, v153
    v_add_f32 v130, v130, v154
    v_add_f32 v131, v131, v155
    v_add_f32 v128, v128, v156
    v_add_f32 v129, v129, v157
    v_add_f32 v130, v130, v158
    v_add_f32 v131, v131, v159
    v_cvt_pk_bf16_f32 v128, v128, v129
    v_cvt_pk_bf16_f32 v129, v130, v131
    v_lshrrev_b32 v48, 1, v48
    s_lshl_b32 s31, s24, 8
    v_add_u32 v48, s31, v48
    ds_write_b64 v48, v[128:129] offset:4096
    s_mov_b64 exec, -1
    v_lshlrev_b32 v49, 6, v2
    v_lshl_add_u32 v49, v5, 4, v49
    v_add_u32 v49, s31, v49
    s_waitcnt lgkmcnt(0)
    ds_read_b128 v[14:17], v49 offset:4096
    s_waitcnt lgkmcnt(0)
    s_waitcnt vmcnt(15)
    v_dot2_f32_bf16 v32, v64, v14, 0
    v_dot2c_f32_bf16 v32, v65, v15
    v_dot2c_f32_bf16 v32, v66, v16
    v_dot2c_f32_bf16 v32, v67, v17
    s_add_u32 s50, s28, 131072
    buffer_load_dwordx4 v[64:67], v6, s[4:7], s50 offen offset:0 nt
    s_waitcnt vmcnt(15)
    v_dot2_f32_bf16 v33, v68, v14, 0
    v_dot2c_f32_bf16 v33, v69, v15
    v_dot2c_f32_bf16 v33, v70, v16
    v_dot2c_f32_bf16 v33, v71, v17
    buffer_load_dwordx4 v[68:71], v6, s[4:7], s50 offen offset:1024 nt
    s_waitcnt vmcnt(15)
    v_dot2_f32_bf16 v34, v72, v14, 0
    v_dot2c_f32_bf16 v34, v73, v15
    v_dot2c_f32_bf16 v34, v74, v16
    v_dot2c_f32_bf16 v34, v75, v17
    buffer_load_dwordx4 v[72:75], v6, s[4:7], s50 offen offset:2048 nt
    s_waitcnt vmcnt(15)
    v_dot2_f32_bf16 v35, v76, v14, 0
    v_dot2c_f32_bf16 v35, v77, v15
    v_dot2c_f32_bf16 v35, v78, v16
    v_dot2c_f32_bf16 v35, v79, v17
    buffer_load_dwordx4 v[76:79], v6, s[4:7], s50 offen offset:3072 nt
    s_waitcnt vmcnt(15)
    v_dot2_f32_bf16 v36, v80, v14, 0
    v_dot2c_f32_bf16 v36, v81, v15
    v_dot2c_f32_bf16 v36, v82, v16
    v_dot2c_f32_bf16 v36, v83, v17
    s_add_u32 s50, s28, 135168
    buffer_load_dwordx4 v[80:83], v6, s[4:7], s50 offen offset:0 nt
    s_waitcnt vmcnt(15)
    v_dot2_f32_bf16 v37, v84, v14, 0
    v_dot2c_f32_bf16 v37, v85, v15
    v_dot2c_f32_bf16 v37, v86, v16
    v_dot2c_f32_bf16 v37, v87, v17
    buffer_load_dwordx4 v[84:87], v6, s[4:7], s50 offen offset:1024 nt
    s_waitcnt vmcnt(15)
    v_dot2_f32_bf16 v38, v88, v14, 0
    v_dot2c_f32_bf16 v38, v89, v15
    v_dot2c_f32_bf16 v38, v90, v16
    v_dot2c_f32_bf16 v38, v91, v17
    buffer_load_dwordx4 v[88:91], v6, s[4:7], s50 offen offset:2048 nt
    s_waitcnt vmcnt(15)
    v_dot2_f32_bf16 v39, v92, v14, 0
    v_dot2c_f32_bf16 v39, v93, v15
    v_dot2c_f32_bf16 v39, v94, v16
    v_dot2c_f32_bf16 v39, v95, v17
    buffer_load_dwordx4 v[92:95], v6, s[4:7], s50 offen offset:3072 nt
    s_waitcnt vmcnt(15)
    v_dot2_f32_bf16 v40, v96, v14, 0
    v_dot2c_f32_bf16 v40, v97, v15
    v_dot2c_f32_bf16 v40, v98, v16
    v_dot2c_f32_bf16 v40, v99, v17
    s_add_u32 s50, s28, 139264
    buffer_load_dwordx4 v[96:99], v6, s[4:7], s50 offen offset:0 nt
    s_waitcnt vmcnt(15)
    v_dot2_f32_bf16 v41, v100, v14, 0
    v_dot2c_f32_bf16 v41, v101, v15
    v_dot2c_f32_bf16 v41, v102, v16
    v_dot2c_f32_bf16 v41, v103, v17
    buffer_load_dwordx4 v[100:103], v6, s[4:7], s50 offen offset:1024 nt
    s_waitcnt vmcnt(15)
    v_dot2_f32_bf16 v42, v104, v14, 0
    v_dot2c_f32_bf16 v42, v105, v15
    v_dot2c_f32_bf16 v42, v106, v16
    v_dot2c_f32_bf16 v42, v107, v17
    buffer_load_dwordx4 v[104:107], v6, s[4:7], s50 offen offset:2048 nt
    s_waitcnt vmcnt(15)
    v_dot2_f32_bf16 v43, v108, v14, 0
    v_dot2c_f32_bf16 v43, v109, v15
    v_dot2c_f32_bf16 v43, v110, v16
    v_dot2c_f32_bf16 v43, v111, v17
    buffer_load_dwordx4 v[108:111], v6, s[4:7], s50 offen offset:3072 nt
    s_waitcnt vmcnt(15)
    v_dot2_f32_bf16 v44, v112, v14, 0
    v_dot2c_f32_bf16 v44, v113, v15
    v_dot2c_f32_bf16 v44, v114, v16
    v_dot2c_f32_bf16 v44, v115, v17
    s_add_u32 s50, s28, 143360
    buffer_load_dwordx4 v[112:115], v6, s[4:7], s50 offen offset:0 nt
    s_waitcnt vmcnt(15)
    v_dot2_f32_bf16 v45, v116, v14, 0
    v_dot2c_f32_bf16 v45, v117, v15
    v_dot2c_f32_bf16 v45, v118, v16
    v_dot2c_f32_bf16 v45, v119, v17
    buffer_load_dwordx4 v[116:119], v6, s[4:7], s50 offen offset:1024 nt
    s_waitcnt vmcnt(15)
    v_dot2_f32_bf16 v46, v120, v14, 0
    v_dot2c_f32_bf16 v46, v121, v15
    v_dot2c_f32_bf16 v46, v122, v16
    v_dot2c_f32_bf16 v46, v123, v17
    buffer_load_dwordx4 v[120:123], v6, s[4:7], s50 offen offset:2048 nt
    s_waitcnt vmcnt(15)
    v_dot2_f32_bf16 v47, v124, v14, 0
    v_dot2c_f32_bf16 v47, v125, v15
    v_dot2c_f32_bf16 v47, v126, v16
    v_dot2c_f32_bf16 v47, v127, v17
    buffer_load_dwordx4 v[124:127], v6, s[4:7], s50 offen offset:3072 nt
    v_permlane32_swap_b32 v32, v40
    v_add_f32 v32, v32, v40
    v_permlane32_swap_b32 v33, v41
    v_add_f32 v33, v33, v41
    v_permlane32_swap_b32 v34, v42
    v_add_f32 v34, v34, v42
    v_permlane32_swap_b32 v35, v43
    v_add_f32 v35, v35, v43
    v_permlane32_swap_b32 v36, v44
    v_add_f32 v36, v36, v44
    v_permlane32_swap_b32 v37, v45
    v_add_f32 v37, v37, v45
    v_permlane32_swap_b32 v38, v46
    v_add_f32 v38, v38, v46
    v_permlane32_swap_b32 v39, v47
    v_add_f32 v39, v39, v47
    v_permlane16_swap_b32 v32, v36
    v_add_f32 v32, v32, v36
    v_permlane16_swap_b32 v33, v37
    v_add_f32 v33, v33, v37
    v_permlane16_swap_b32 v34, v38
    v_add_f32 v34, v34, v38
    v_permlane16_swap_b32 v35, v39
    v_add_f32 v35, v35, v39
    v_cndmask_b32 v48, v32, v34, s[32:33]
    v_cndmask_b32 v49, v34, v32, s[32:33]
    s_nop 1
    v_add_f32_dpp v32, v49, v48 quad_perm:[2,3,0,1] row_mask:0xf bank_mask:0xf
    v_cndmask_b32 v48, v33, v35, s[32:33]
    v_cndmask_b32 v49, v35, v33, s[32:33]
    s_nop 1
    v_add_f32_dpp v33, v49, v48 quad_perm:[2,3,0,1] row_mask:0xf bank_mask:0xf
    v_cndmask_b32 v48, v32, v33, s[34:35]
    v_cndmask_b32 v49, v33, v32, s[34:35]
    s_nop 1
    v_add_f32_dpp v18, v49, v48 quad_perm:[1,0,3,2] row_mask:0xf bank_mask:0xf
    s_waitcnt vmcnt(15)
    v_dot2_f32_bf16 v32, v64, v14, 0
    v_dot2c_f32_bf16 v32, v65, v15
    v_dot2c_f32_bf16 v32, v66, v16
    v_dot2c_f32_bf16 v32, v67, v17
    s_add_u32 s51, s28, 0
    buffer_load_dwordx4 v[64:67], v7, s[8:11], s51 offen offset:0 nt
    s_waitcnt vmcnt(15)
    v_dot2_f32_bf16 v33, v68, v14, 0
    v_dot2c_f32_bf16 v33, v69, v15
    v_dot2c_f32_bf16 v33, v70, v16
    v_dot2c_f32_bf16 v33, v71, v17
    buffer_load_dwordx4 v[68:71], v7, s[8:11], s51 offen offset:1024 nt
    s_waitcnt vmcnt(15)
    v_dot2_f32_bf16 v34, v72, v14, 0
    v_dot2c_f32_bf16 v34, v73, v15
    v_dot2c_f32_bf16 v34, v74, v16
    v_dot2c_f32_bf16 v34, v75, v17
    buffer_load_dwordx4 v[72:75], v7, s[8:11], s51 offen offset:2048 nt
    s_waitcnt vmcnt(15)
    v_dot2_f32_bf16 v35, v76, v14, 0
    v_dot2c_f32_bf16 v35, v77, v15
    v_dot2c_f32_bf16 v35, v78, v16
    v_dot2c_f32_bf16 v35, v79, v17
    buffer_load_dwordx4 v[76:79], v7, s[8:11], s51 offen offset:3072 nt
    s_waitcnt vmcnt(15)
    v_dot2_f32_bf16 v36, v80, v14, 0
    v_dot2c_f32_bf16 v36, v81, v15
    v_dot2c_f32_bf16 v36, v82, v16
    v_dot2c_f32_bf16 v36, v83, v17
    buffer_load_dwordx4 v[80:83], v7, s[8:11], s51 offen offset:256 nt
    s_waitcnt vmcnt(15)
    v_dot2_f32_bf16 v37, v84, v14, 0
    v_dot2c_f32_bf16 v37, v85, v15
    v_dot2c_f32_bf16 v37, v86, v16
    v_dot2c_f32_bf16 v37, v87, v17
    buffer_load_dwordx4 v[84:87], v7, s[8:11], s51 offen offset:1280 nt
    s_waitcnt vmcnt(15)
    v_dot2_f32_bf16 v38, v88, v14, 0
    v_dot2c_f32_bf16 v38, v89, v15
    v_dot2c_f32_bf16 v38, v90, v16
    v_dot2c_f32_bf16 v38, v91, v17
    buffer_load_dwordx4 v[88:91], v7, s[8:11], s51 offen offset:2304 nt
    s_waitcnt vmcnt(15)
    v_dot2_f32_bf16 v39, v92, v14, 0
    v_dot2c_f32_bf16 v39, v93, v15
    v_dot2c_f32_bf16 v39, v94, v16
    v_dot2c_f32_bf16 v39, v95, v17
    buffer_load_dwordx4 v[92:95], v7, s[8:11], s51 offen offset:3328 nt
    s_waitcnt vmcnt(15)
    v_dot2_f32_bf16 v40, v96, v14, 0
    v_dot2c_f32_bf16 v40, v97, v15
    v_dot2c_f32_bf16 v40, v98, v16
    v_dot2c_f32_bf16 v40, v99, v17
    buffer_load_dwordx4 v[96:99], v7, s[8:11], s51 offen offset:512 nt
    s_waitcnt vmcnt(15)
    v_dot2_f32_bf16 v41, v100, v14, 0
    v_dot2c_f32_bf16 v41, v101, v15
    v_dot2c_f32_bf16 v41, v102, v16
    v_dot2c_f32_bf16 v41, v103, v17
    buffer_load_dwordx4 v[100:103], v7, s[8:11], s51 offen offset:1536 nt
    s_waitcnt vmcnt(15)
    v_dot2_f32_bf16 v42, v104, v14, 0
    v_dot2c_f32_bf16 v42, v105, v15
    v_dot2c_f32_bf16 v42, v106, v16
    v_dot2c_f32_bf16 v42, v107, v17
    buffer_load_dwordx4 v[104:107], v7, s[8:11], s51 offen offset:2560 nt
    s_waitcnt vmcnt(15)
    v_dot2_f32_bf16 v43, v108, v14, 0
    v_dot2c_f32_bf16 v43, v109, v15
    v_dot2c_f32_bf16 v43, v110, v16
    v_dot2c_f32_bf16 v43, v111, v17
    buffer_load_dwordx4 v[108:111], v7, s[8:11], s51 offen offset:3584 nt
    s_waitcnt vmcnt(15)
    v_dot2_f32_bf16 v44, v112, v14, 0
    v_dot2c_f32_bf16 v44, v113, v15
    v_dot2c_f32_bf16 v44, v114, v16
    v_dot2c_f32_bf16 v44, v115, v17
    buffer_load_dwordx4 v[112:115], v7, s[8:11], s51 offen offset:768 nt
    s_waitcnt vmcnt(15)
    v_dot2_f32_bf16 v45, v116, v14, 0
    v_dot2c_f32_bf16 v45, v117, v15
    v_dot2c_f32_bf16 v45, v118, v16
    v_dot2c_f32_bf16 v45, v119, v17
    buffer_load_dwordx4 v[116:119], v7, s[8:11], s51 offen offset:1792 nt
    s_waitcnt vmcnt(15)
    v_dot2_f32_bf16 v46, v120, v14, 0
    v_dot2c_f32_bf16 v46, v121, v15
    v_dot2c_f32_bf16 v46, v122, v16
    v_dot2c_f32_bf16 v46, v123, v17
    buffer_load_dwordx4 v[120:123], v7, s[8:11], s51 offen offset:2816 nt
    s_waitcnt vmcnt(15)
    v_dot2_f32_bf16 v47, v124, v14, 0
    v_dot2c_f32_bf16 v47, v125, v15
    v_dot2c_f32_bf16 v47, v126, v16
    v_dot2c_f32_bf16 v47, v127, v17
    buffer_load_dwordx4 v[124:127], v7, s[8:11], s51 offen offset:3840 nt
    v_permlane32_swap_b32 v32, v40
    v_add_f32 v32, v32, v40
    v_permlane32_swap_b32 v33, v41
    v_add_f32 v33, v33, v41
    v_permlane32_swap_b32 v34, v42
    v_add_f32 v34, v34, v42
    v_permlane32_swap_b32 v35, v43
    v_add_f32 v35, v35, v43
    v_permlane32_swap_b32 v36, v44
    v_add_f32 v36, v36, v44
    v_permlane32_swap_b32 v37, v45
    v_add_f32 v37, v37, v45
    v_permlane32_swap_b32 v38, v46
    v_add_f32 v38, v38, v46
    v_permlane32_swap_b32 v39, v47
    v_add_f32 v39, v39, v47
    v_permlane16_swap_b32 v32, v36
    v_add_f32 v32, v32, v36
    v_permlane16_swap_b32 v33, v37
    v_add_f32 v33, v33, v37
    v_permlane16_swap_b32 v34, v38
    v_add_f32 v34, v34, v38
    v_permlane16_swap_b32 v35, v39
    v_add_f32 v35, v35, v39
    v_cndmask_b32 v48, v32, v34, s[32:33]
    v_cndmask_b32 v49, v34, v32, s[32:33]
    s_nop 1
    v_add_f32_dpp v32, v49, v48 quad_perm:[2,3,0,1] row_mask:0xf bank_mask:0xf
    v_cndmask_b32 v48, v33, v35, s[32:33]
    v_cndmask_b32 v49, v35, v33, s[32:33]
    s_nop 1
    v_add_f32_dpp v33, v49, v48 quad_perm:[2,3,0,1] row_mask:0xf bank_mask:0xf
    v_cndmask_b32 v48, v32, v33, s[34:35]
    v_cndmask_b32 v49, v33, v32, s[34:35]
    s_nop 1
    v_add_f32_dpp v19, v49, v48 quad_perm:[1,0,3,2] row_mask:0xf bank_mask:0xf
    v_max_f32 v23, v18, v19
    s_nop 1
    v_max_f32_dpp v23, v23, v23 row_ror:8 row_mask:0xf bank_mask:0xf
    s_nop 1
    v_max_f32_dpp v23, v23, v23 row_ror:4 row_mask:0xf bank_mask:0xf
    s_nop 1
    v_max_f32_dpp v23, v23, v23 row_ror:2 row_mask:0xf bank_mask:0xf
    s_nop 1
    v_max_f32_dpp v23, v23, v23 row_ror:1 row_mask:0xf bank_mask:0xf
    v_mov_b32 v48, v23
    v_mov_b32 v49, v23
    s_nop 1
    v_permlane16_swap_b32 v48, v49
    v_max_f32 v23, v48, v49
    v_mov_b32 v48, v23
    v_mov_b32 v49, v23
    s_nop 1
    v_permlane32_swap_b32 v48, v49
    v_max_f32 v23, v48, v49
    s_mov_b32 s36, 0x3e0293ee
    v_mul_f32 v23, s36, v23
    v_fma_f32 v18, v18, s36, -v23
    v_fma_f32 v19, v19, s36, -v23
    v_exp_f32 v18, v18
    v_exp_f32 v19, v19
    v_cvt_pk_bf16_f32 v20, v18, v18
    v_cvt_pk_bf16_f32 v21, v19, v19
    v_and_b32 v48, 0xffff0000, v20
    v_and_b32 v49, 0xffff0000, v21
    v_add_f32 v22, v48, v49
    v_mov_b32 v24, 0
    v_mov_b32 v25, 0
    v_mov_b32 v26, 0
    v_mov_b32 v27, 0
    v_add_f32_dpp v22, v22, v22 row_ror:8 row_mask:0xf bank_mask:0xf
    s_nop 1
    v_add_f32_dpp v22, v22, v22 row_ror:4 row_mask:0xf bank_mask:0xf
    s_nop 1
    v_add_f32_dpp v22, v22, v22 row_ror:2 row_mask:0xf bank_mask:0xf
    s_nop 1
    v_add_f32_dpp v22, v22, v22 row_ror:1 row_mask:0xf bank_mask:0xf
    v_mov_b32 v48, v22
    v_mov_b32 v49, v22
    s_nop 1
    v_permlane16_swap_b32 v48, v49
    v_add_f32 v22, v48, v49
    v_mov_b32 v48, v22
    v_mov_b32 v49, v22
    s_nop 1
    v_permlane32_swap_b32 v48, v49
    v_add_f32 v22, v48, v49
    s_waitcnt vmcnt(15)
    v_and_b32_dpp v28, v20, v10 row_newbcast:0 row_mask:0xf bank_mask:0xf
    v_and_b32_dpp v29, v20, v11 row_newbcast:0 row_mask:0xf bank_mask:0xf
    v_and_b32_dpp v30, v20, v12 row_newbcast:0 row_mask:0xf bank_mask:0xf
    v_and_b32_dpp v31, v20, v13 row_newbcast:0 row_mask:0xf bank_mask:0xf
    s_nop 1
    v_mfma_f32_16x16x32_bf16 v[24:27], v[28:31], v[64:67], v[24:27]
    s_add_u32 s51, s28, 131072
    buffer_load_dwordx4 v[64:67], v7, s[8:11], s51 offen offset:0 nt
    s_waitcnt vmcnt(15)
    v_and_b32_dpp v28, v20, v10 row_newbcast:1 row_mask:0xf bank_mask:0xf
    v_and_b32_dpp v29, v20, v11 row_newbcast:1 row_mask:0xf bank_mask:0xf
    v_and_b32_dpp v30, v20, v12 row_newbcast:1 row_mask:0xf bank_mask:0xf
    v_and_b32_dpp v31, v20, v13 row_newbcast:1 row_mask:0xf bank_mask:0xf
    s_nop 1
    v_mfma_f32_16x16x32_bf16 v[24:27], v[28:31], v[68:71], v[24:27]
    buffer_load_dwordx4 v[68:71], v7, s[8:11], s51 offen offset:1024 nt
    s_waitcnt vmcnt(15)
    v_and_b32_dpp v28, v20, v10 row_newbcast:2 row_mask:0xf bank_mask:0xf
    v_and_b32_dpp v29, v20, v11 row_newbcast:2 row_mask:0xf bank_mask:0xf
    v_and_b32_dpp v30, v20, v12 row_newbcast:2 row_mask:0xf bank_mask:0xf
    v_and_b32_dpp v31, v20, v13 row_newbcast:2 row_mask:0xf bank_mask:0xf
    s_nop 1
    v_mfma_f32_16x16x32_bf16 v[24:27], v[28:31], v[72:75], v[24:27]
    buffer_load_dwordx4 v[72:75], v7, s[8:11], s51 offen offset:2048 nt
    s_waitcnt vmcnt(15)
    v_and_b32_dpp v28, v20, v10 row_newbcast:3 row_mask:0xf bank_mask:0xf
    v_and_b32_dpp v29, v20, v11 row_newbcast:3 row_mask:0xf bank_mask:0xf
    v_and_b32_dpp v30, v20, v12 row_newbcast:3 row_mask:0xf bank_mask:0xf
    v_and_b32_dpp v31, v20, v13 row_newbcast:3 row_mask:0xf bank_mask:0xf
    s_nop 1
    v_mfma_f32_16x16x32_bf16 v[24:27], v[28:31], v[76:79], v[24:27]
    buffer_load_dwordx4 v[76:79], v7, s[8:11], s51 offen offset:3072 nt
    s_waitcnt vmcnt(15)
    v_and_b32_dpp v28, v20, v10 row_newbcast:4 row_mask:0xf bank_mask:0xf
    v_and_b32_dpp v29, v20, v11 row_newbcast:4 row_mask:0xf bank_mask:0xf
    v_and_b32_dpp v30, v20, v12 row_newbcast:4 row_mask:0xf bank_mask:0xf
    v_and_b32_dpp v31, v20, v13 row_newbcast:4 row_mask:0xf bank_mask:0xf
    s_nop 1
    v_mfma_f32_16x16x32_bf16 v[24:27], v[28:31], v[80:83], v[24:27]
    buffer_load_dwordx4 v[80:83], v7, s[8:11], s51 offen offset:256 nt
    s_waitcnt vmcnt(15)
    v_and_b32_dpp v28, v20, v10 row_newbcast:5 row_mask:0xf bank_mask:0xf
    v_and_b32_dpp v29, v20, v11 row_newbcast:5 row_mask:0xf bank_mask:0xf
    v_and_b32_dpp v30, v20, v12 row_newbcast:5 row_mask:0xf bank_mask:0xf
    v_and_b32_dpp v31, v20, v13 row_newbcast:5 row_mask:0xf bank_mask:0xf
    s_nop 1
    v_mfma_f32_16x16x32_bf16 v[24:27], v[28:31], v[84:87], v[24:27]
    buffer_load_dwordx4 v[84:87], v7, s[8:11], s51 offen offset:1280 nt
    s_waitcnt vmcnt(15)
    v_and_b32_dpp v28, v20, v10 row_newbcast:6 row_mask:0xf bank_mask:0xf
    v_and_b32_dpp v29, v20, v11 row_newbcast:6 row_mask:0xf bank_mask:0xf
    v_and_b32_dpp v30, v20, v12 row_newbcast:6 row_mask:0xf bank_mask:0xf
    v_and_b32_dpp v31, v20, v13 row_newbcast:6 row_mask:0xf bank_mask:0xf
    s_nop 1
    v_mfma_f32_16x16x32_bf16 v[24:27], v[28:31], v[88:91], v[24:27]
    buffer_load_dwordx4 v[88:91], v7, s[8:11], s51 offen offset:2304 nt
    s_waitcnt vmcnt(15)
    v_and_b32_dpp v28, v20, v10 row_newbcast:7 row_mask:0xf bank_mask:0xf
    v_and_b32_dpp v29, v20, v11 row_newbcast:7 row_mask:0xf bank_mask:0xf
    v_and_b32_dpp v30, v20, v12 row_newbcast:7 row_mask:0xf bank_mask:0xf
    v_and_b32_dpp v31, v20, v13 row_newbcast:7 row_mask:0xf bank_mask:0xf
    s_nop 1
    v_mfma_f32_16x16x32_bf16 v[24:27], v[28:31], v[92:95], v[24:27]
    buffer_load_dwordx4 v[92:95], v7, s[8:11], s51 offen offset:3328 nt
    s_waitcnt vmcnt(15)
    v_and_b32_dpp v28, v20, v10 row_newbcast:8 row_mask:0xf bank_mask:0xf
    v_and_b32_dpp v29, v20, v11 row_newbcast:8 row_mask:0xf bank_mask:0xf
    v_and_b32_dpp v30, v20, v12 row_newbcast:8 row_mask:0xf bank_mask:0xf
    v_and_b32_dpp v31, v20, v13 row_newbcast:8 row_mask:0xf bank_mask:0xf
    s_nop 1
    v_mfma_f32_16x16x32_bf16 v[24:27], v[28:31], v[96:99], v[24:27]
    buffer_load_dwordx4 v[96:99], v7, s[8:11], s51 offen offset:512 nt
    s_waitcnt vmcnt(15)
    v_and_b32_dpp v28, v20, v10 row_newbcast:9 row_mask:0xf bank_mask:0xf
    v_and_b32_dpp v29, v20, v11 row_newbcast:9 row_mask:0xf bank_mask:0xf
    v_and_b32_dpp v30, v20, v12 row_newbcast:9 row_mask:0xf bank_mask:0xf
    v_and_b32_dpp v31, v20, v13 row_newbcast:9 row_mask:0xf bank_mask:0xf
    s_nop 1
    v_mfma_f32_16x16x32_bf16 v[24:27], v[28:31], v[100:103], v[24:27]
    buffer_load_dwordx4 v[100:103], v7, s[8:11], s51 offen offset:1536 nt
    s_waitcnt vmcnt(15)
    v_and_b32_dpp v28, v20, v10 row_newbcast:10 row_mask:0xf bank_mask:0xf
    v_and_b32_dpp v29, v20, v11 row_newbcast:10 row_mask:0xf bank_mask:0xf
    v_and_b32_dpp v30, v20, v12 row_newbcast:10 row_mask:0xf bank_mask:0xf
    v_and_b32_dpp v31, v20, v13 row_newbcast:10 row_mask:0xf bank_mask:0xf
    s_nop 1
    v_mfma_f32_16x16x32_bf16 v[24:27], v[28:31], v[104:107], v[24:27]
    buffer_load_dwordx4 v[104:107], v7, s[8:11], s51 offen offset:2560 nt
    s_waitcnt vmcnt(15)
    v_and_b32_dpp v28, v20, v10 row_newbcast:11 row_mask:0xf bank_mask:0xf
    v_and_b32_dpp v29, v20, v11 row_newbcast:11 row_mask:0xf bank_mask:0xf
    v_and_b32_dpp v30, v20, v12 row_newbcast:11 row_mask:0xf bank_mask:0xf
    v_and_b32_dpp v31, v20, v13 row_newbcast:11 row_mask:0xf bank_mask:0xf
    s_nop 1
    v_mfma_f32_16x16x32_bf16 v[24:27], v[28:31], v[108:111], v[24:27]
    buffer_load_dwordx4 v[108:111], v7, s[8:11], s51 offen offset:3584 nt
    s_waitcnt vmcnt(15)
    v_and_b32_dpp v28, v20, v10 row_newbcast:12 row_mask:0xf bank_mask:0xf
    v_and_b32_dpp v29, v20, v11 row_newbcast:12 row_mask:0xf bank_mask:0xf
    v_and_b32_dpp v30, v20, v12 row_newbcast:12 row_mask:0xf bank_mask:0xf
    v_and_b32_dpp v31, v20, v13 row_newbcast:12 row_mask:0xf bank_mask:0xf
    s_nop 1
    v_mfma_f32_16x16x32_bf16 v[24:27], v[28:31], v[112:115], v[24:27]
    buffer_load_dwordx4 v[112:115], v7, s[8:11], s51 offen offset:768 nt
    s_waitcnt vmcnt(15)
    v_and_b32_dpp v28, v20, v10 row_newbcast:13 row_mask:0xf bank_mask:0xf
    v_and_b32_dpp v29, v20, v11 row_newbcast:13 row_mask:0xf bank_mask:0xf
    v_and_b32_dpp v30, v20, v12 row_newbcast:13 row_mask:0xf bank_mask:0xf
    v_and_b32_dpp v31, v20, v13 row_newbcast:13 row_mask:0xf bank_mask:0xf
    s_nop 1
    v_mfma_f32_16x16x32_bf16 v[24:27], v[28:31], v[116:119], v[24:27]
    buffer_load_dwordx4 v[116:119], v7, s[8:11], s51 offen offset:1792 nt
    s_waitcnt vmcnt(15)
    v_and_b32_dpp v28, v20, v10 row_newbcast:14 row_mask:0xf bank_mask:0xf
    v_and_b32_dpp v29, v20, v11 row_newbcast:14 row_mask:0xf bank_mask:0xf
    v_and_b32_dpp v30, v20, v12 row_newbcast:14 row_mask:0xf bank_mask:0xf
    v_and_b32_dpp v31, v20, v13 row_newbcast:14 row_mask:0xf bank_mask:0xf
    s_nop 1
    v_mfma_f32_16x16x32_bf16 v[24:27], v[28:31], v[120:123], v[24:27]
    buffer_load_dwordx4 v[120:123], v7, s[8:11], s51 offen offset:2816 nt
    s_waitcnt vmcnt(15)
    v_and_b32_dpp v28, v20, v10 row_newbcast:15 row_mask:0xf bank_mask:0xf
    v_and_b32_dpp v29, v20, v11 row_newbcast:15 row_mask:0xf bank_mask:0xf
    v_and_b32_dpp v30, v20, v12 row_newbcast:15 row_mask:0xf bank_mask:0xf
    v_and_b32_dpp v31, v20, v13 row_newbcast:15 row_mask:0xf bank_mask:0xf
    s_nop 1
    v_mfma_f32_16x16x32_bf16 v[24:27], v[28:31], v[124:127], v[24:27]
    buffer_load_dwordx4 v[124:127], v7, s[8:11], s51 offen offset:3840 nt
    s_waitcnt vmcnt(15)
    v_and_b32_dpp v28, v21, v10 row_newbcast:0 row_mask:0xf bank_mask:0xf
    v_and_b32_dpp v29, v21, v11 row_newbcast:0 row_mask:0xf bank_mask:0xf
    v_and_b32_dpp v30, v21, v12 row_newbcast:0 row_mask:0xf bank_mask:0xf
    v_and_b32_dpp v31, v21, v13 row_newbcast:0 row_mask:0xf bank_mask:0xf
    s_nop 1
    v_mfma_f32_16x16x32_bf16 v[24:27], v[28:31], v[64:67], v[24:27]
    s_waitcnt vmcnt(14)
    v_and_b32_dpp v28, v21, v10 row_newbcast:1 row_mask:0xf bank_mask:0xf
    v_and_b32_dpp v29, v21, v11 row_newbcast:1 row_mask:0xf bank_mask:0xf
    v_and_b32_dpp v30, v21, v12 row_newbcast:1 row_mask:0xf bank_mask:0xf
    v_and_b32_dpp v31, v21, v13 row_newbcast:1 row_mask:0xf bank_mask:0xf
    s_nop 1
    v_mfma_f32_16x16x32_bf16 v[24:27], v[28:31], v[68:71], v[24:27]
    s_waitcnt vmcnt(13)
    v_and_b32_dpp v28, v21, v10 row_newbcast:2 row_mask:0xf bank_mask:0xf
    v_and_b32_dpp v29, v21, v11 row_newbcast:2 row_mask:0xf bank_mask:0xf
    v_and_b32_dpp v30, v21, v12 row_newbcast:2 row_mask:0xf bank_mask:0xf
    v_and_b32_dpp v31, v21, v13 row_newbcast:2 row_mask:0xf bank_mask:0xf
    s_nop 1
    v_mfma_f32_16x16x32_bf16 v[24:27], v[28:31], v[72:75], v[24:27]
    s_waitcnt vmcnt(12)
    v_and_b32_dpp v28, v21, v10 row_newbcast:3 row_mask:0xf bank_mask:0xf
    v_and_b32_dpp v29, v21, v11 row_newbcast:3 row_mask:0xf bank_mask:0xf
    v_and_b32_dpp v30, v21, v12 row_newbcast:3 row_mask:0xf bank_mask:0xf
    v_and_b32_dpp v31, v21, v13 row_newbcast:3 row_mask:0xf bank_mask:0xf
    s_nop 1
    v_mfma_f32_16x16x32_bf16 v[24:27], v[28:31], v[76:79], v[24:27]
    s_waitcnt vmcnt(11)
    v_and_b32_dpp v28, v21, v10 row_newbcast:4 row_mask:0xf bank_mask:0xf
    v_and_b32_dpp v29, v21, v11 row_newbcast:4 row_mask:0xf bank_mask:0xf
    v_and_b32_dpp v30, v21, v12 row_newbcast:4 row_mask:0xf bank_mask:0xf
    v_and_b32_dpp v31, v21, v13 row_newbcast:4 row_mask:0xf bank_mask:0xf
    s_nop 1
    v_mfma_f32_16x16x32_bf16 v[24:27], v[28:31], v[80:83], v[24:27]
    s_waitcnt vmcnt(10)
    v_and_b32_dpp v28, v21, v10 row_newbcast:5 row_mask:0xf bank_mask:0xf
    v_and_b32_dpp v29, v21, v11 row_newbcast:5 row_mask:0xf bank_mask:0xf
    v_and_b32_dpp v30, v21, v12 row_newbcast:5 row_mask:0xf bank_mask:0xf
    v_and_b32_dpp v31, v21, v13 row_newbcast:5 row_mask:0xf bank_mask:0xf
    s_nop 1
    v_mfma_f32_16x16x32_bf16 v[24:27], v[28:31], v[84:87], v[24:27]
    s_waitcnt vmcnt(9)
    v_and_b32_dpp v28, v21, v10 row_newbcast:6 row_mask:0xf bank_mask:0xf
    v_and_b32_dpp v29, v21, v11 row_newbcast:6 row_mask:0xf bank_mask:0xf
    v_and_b32_dpp v30, v21, v12 row_newbcast:6 row_mask:0xf bank_mask:0xf
    v_and_b32_dpp v31, v21, v13 row_newbcast:6 row_mask:0xf bank_mask:0xf
    s_nop 1
    v_mfma_f32_16x16x32_bf16 v[24:27], v[28:31], v[88:91], v[24:27]
    s_waitcnt vmcnt(8)
    v_and_b32_dpp v28, v21, v10 row_newbcast:7 row_mask:0xf bank_mask:0xf
    v_and_b32_dpp v29, v21, v11 row_newbcast:7 row_mask:0xf bank_mask:0xf
    v_and_b32_dpp v30, v21, v12 row_newbcast:7 row_mask:0xf bank_mask:0xf
    v_and_b32_dpp v31, v21, v13 row_newbcast:7 row_mask:0xf bank_mask:0xf
    s_nop 1
    v_mfma_f32_16x16x32_bf16 v[24:27], v[28:31], v[92:95], v[24:27]
    s_waitcnt vmcnt(7)
    v_and_b32_dpp v28, v21, v10 row_newbcast:8 row_mask:0xf bank_mask:0xf
    v_and_b32_dpp v29, v21, v11 row_newbcast:8 row_mask:0xf bank_mask:0xf
    v_and_b32_dpp v30, v21, v12 row_newbcast:8 row_mask:0xf bank_mask:0xf
    v_and_b32_dpp v31, v21, v13 row_newbcast:8 row_mask:0xf bank_mask:0xf
    s_nop 1
    v_mfma_f32_16x16x32_bf16 v[24:27], v[28:31], v[96:99], v[24:27]
    s_waitcnt vmcnt(6)
    v_and_b32_dpp v28, v21, v10 row_newbcast:9 row_mask:0xf bank_mask:0xf
    v_and_b32_dpp v29, v21, v11 row_newbcast:9 row_mask:0xf bank_mask:0xf
    v_and_b32_dpp v30, v21, v12 row_newbcast:9 row_mask:0xf bank_mask:0xf
    v_and_b32_dpp v31, v21, v13 row_newbcast:9 row_mask:0xf bank_mask:0xf
    s_nop 1
    v_mfma_f32_16x16x32_bf16 v[24:27], v[28:31], v[100:103], v[24:27]
    s_waitcnt vmcnt(5)
    v_and_b32_dpp v28, v21, v10 row_newbcast:10 row_mask:0xf bank_mask:0xf
    v_and_b32_dpp v29, v21, v11 row_newbcast:10 row_mask:0xf bank_mask:0xf
    v_and_b32_dpp v30, v21, v12 row_newbcast:10 row_mask:0xf bank_mask:0xf
    v_and_b32_dpp v31, v21, v13 row_newbcast:10 row_mask:0xf bank_mask:0xf
    s_nop 1
    v_mfma_f32_16x16x32_bf16 v[24:27], v[28:31], v[104:107], v[24:27]
    s_waitcnt vmcnt(4)
    v_and_b32_dpp v28, v21, v10 row_newbcast:11 row_mask:0xf bank_mask:0xf
    v_and_b32_dpp v29, v21, v11 row_newbcast:11 row_mask:0xf bank_mask:0xf
    v_and_b32_dpp v30, v21, v12 row_newbcast:11 row_mask:0xf bank_mask:0xf
    v_and_b32_dpp v31, v21, v13 row_newbcast:11 row_mask:0xf bank_mask:0xf
    s_nop 1
    v_mfma_f32_16x16x32_bf16 v[24:27], v[28:31], v[108:111], v[24:27]
    s_waitcnt vmcnt(3)
    v_and_b32_dpp v28, v21, v10 row_newbcast:12 row_mask:0xf bank_mask:0xf
    v_and_b32_dpp v29, v21, v11 row_newbcast:12 row_mask:0xf bank_mask:0xf
    v_and_b32_dpp v30, v21, v12 row_newbcast:12 row_mask:0xf bank_mask:0xf
    v_and_b32_dpp v31, v21, v13 row_newbcast:12 row_mask:0xf bank_mask:0xf
    s_nop 1
    v_mfma_f32_16x16x32_bf16 v[24:27], v[28:31], v[112:115], v[24:27]
    s_waitcnt vmcnt(2)
    v_and_b32_dpp v28, v21, v10 row_newbcast:13 row_mask:0xf bank_mask:0xf
    v_and_b32_dpp v29, v21, v11 row_newbcast:13 row_mask:0xf bank_mask:0xf
    v_and_b32_dpp v30, v21, v12 row_newbcast:13 row_mask:0xf bank_mask:0xf
    v_and_b32_dpp v31, v21, v13 row_newbcast:13 row_mask:0xf bank_mask:0xf
    s_nop 1
    v_mfma_f32_16x16x32_bf16 v[24:27], v[28:31], v[116:119], v[24:27]
    s_waitcnt vmcnt(1)
    v_and_b32_dpp v28, v21, v10 row_newbcast:14 row_mask:0xf bank_mask:0xf
    v_and_b32_dpp v29, v21, v11 row_newbcast:14 row_mask:0xf bank_mask:0xf
    v_and_b32_dpp v30, v21, v12 row_newbcast:14 row_mask:0xf bank_mask:0xf
    v_and_b32_dpp v31, v21, v13 row_newbcast:14 row_mask:0xf bank_mask:0xf
    s_nop 1
    v_mfma_f32_16x16x32_bf16 v[24:27], v[28:31], v[120:123], v[24:27]
    s_waitcnt vmcnt(0)
    v_and_b32_dpp v28, v21, v10 row_newbcast:15 row_mask:0xf bank_mask:0xf
    v_and_b32_dpp v29, v21, v11 row_newbcast:15 row_mask:0xf bank_mask:0xf
    v_and_b32_dpp v30, v21, v12 row_newbcast:15 row_mask:0xf bank_mask:0xf
    v_and_b32_dpp v31, v21, v13 row_newbcast:15 row_mask:0xf bank_mask:0xf
    s_nop 1
    v_mfma_f32_16x16x32_bf16 v[24:27], v[28:31], v[124:127], v[24:27]
    v_lshlrev_b32 v48, 5, v3
    v_lshl_add_u32 v48, v2, 4, v48
    s_lshl_b32 s31, s24, 9
    v_add_u32 v49, s31, v48
    s_lshl_b32 s31, s24, 3
    v_mov_b32 v50, s31
    v_mov_b32 v52, v23
    v_mov_b32 v53, v22
    s_mov_b32 exec_lo, -1
    s_mov_b32 exec_hi, 0
    ds_write_b128 v49, v[24:27] offset:6144
    s_mov_b64 exec, 1
    ds_write_b64 v50, v[52:53] offset:10240
    s_mov_b64 exec, -1
    s_waitcnt lgkmcnt(0)
    s_barrier
    s_cmp_lg_u32 s24, 0
    s_cbranch_scc1 A_done_2
    v_mov_b32 v50, 0
    ds_read_b128 v[64:67], v50 offset:10240
    ds_read_b128 v[68:71], v50 offset:10256
    ds_read_b128 v[72:75], v50 offset:10272
    ds_read_b128 v[76:79], v50 offset:10288
    ds_read_b128 v[80:83], v48 offset:6144
    ds_read_b128 v[84:87], v48 offset:6656
    ds_read_b128 v[88:91], v48 offset:7168
    ds_read_b128 v[92:95], v48 offset:7680
    ds_read_b128 v[96:99], v48 offset:8192
    ds_read_b128 v[100:103], v48 offset:8704
    ds_read_b128 v[104:107], v48 offset:9216
    ds_read_b128 v[108:111], v48 offset:9728
    s_waitcnt lgkmcnt(0)
    v_max3_f32 v56, v64, v66, v68
    v_max3_f32 v56, v56, v70, v72
    v_max3_f32 v56, v56, v74, v76
    v_max_f32 v56, v56, v78
    v_sub_f32 v64, v64, v56
    v_exp_f32 v64, v64
    v_sub_f32 v66, v66, v56
    v_exp_f32 v66, v66
    v_sub_f32 v68, v68, v56
    v_exp_f32 v68, v68
    v_sub_f32 v70, v70, v56
    v_exp_f32 v70, v70
    v_sub_f32 v72, v72, v56
    v_exp_f32 v72, v72
    v_sub_f32 v74, v74, v56
    v_exp_f32 v74, v74
    v_sub_f32 v76, v76, v56
    v_exp_f32 v76, v76
    v_sub_f32 v78, v78, v56
    v_exp_f32 v78, v78
    v_mul_f32 v57, v64, v65
    v_fmac_f32 v57, v66, v67
    v_fmac_f32 v57, v68, v69
    v_fmac_f32 v57, v70, v71
    v_fmac_f32 v57, v72, v73
    v_fmac_f32 v57, v74, v75
    v_fmac_f32 v57, v76, v77
    v_fmac_f32 v57, v78, v79
    v_mul_f32 v60, v64, v80
    v_mul_f32 v61, v64, v81
    v_mul_f32 v62, v64, v82
    v_mul_f32 v63, v64, v83
    v_fmac_f32 v60, v66, v84
    v_fmac_f32 v61, v66, v85
    v_fmac_f32 v62, v66, v86
    v_fmac_f32 v63, v66, v87
    v_fmac_f32 v60, v68, v88
    v_fmac_f32 v61, v68, v89
    v_fmac_f32 v62, v68, v90
    v_fmac_f32 v63, v68, v91
    v_fmac_f32 v60, v70, v92
    v_fmac_f32 v61, v70, v93
    v_fmac_f32 v62, v70, v94
    v_fmac_f32 v63, v70, v95
    v_fmac_f32 v60, v72, v96
    v_fmac_f32 v61, v72, v97
    v_fmac_f32 v62, v72, v98
    v_fmac_f32 v63, v72, v99
    v_fmac_f32 v60, v74, v100
    v_fmac_f32 v61, v74, v101
    v_fmac_f32 v62, v74, v102
    v_fmac_f32 v63, v74, v103
    v_fmac_f32 v60, v76, v104
    v_fmac_f32 v61, v76, v105
    v_fmac_f32 v62, v76, v106
    v_fmac_f32 v63, v76, v107
    v_fmac_f32 v60, v78, v108
    v_fmac_f32 v61, v78, v109
    v_fmac_f32 v62, v78, v110
    v_fmac_f32 v63, v78, v111
    s_lshl_b32 s31, s53, 10
    s_add_u32 s31, s31, 0
    s_mov_b32 exec_lo, -1
    s_mov_b32 exec_hi, 0
    buffer_store_dwordx4 v[60:63], v48, s[20:23], s31 offen sc1
    s_mov_b64 exec, 1
    buffer_store_dwordx2 v[56:57], v50, s[20:23], s31 offen offset:512 sc1
    s_waitcnt vmcnt(0)
    v_mov_b32 v49, 1
    s_lshl_b32 s31, s25, 2
    buffer_atomic_add v49, v50, s[56:59], s31 offen offset:64
    s_mov_b64 exec, -1
A_done_2:
    s_branch main_end
main_A3:
    v_lshlrev_b32 v6, 8, v4
    v_lshl_add_u32 v6, v2, 6, v6
    v_lshl_add_u32 v6, v5, 4, v6
    v_lshlrev_b32 v48, 4, v3
    v_lshl_add_u32 v7, v2, 12, v48
    v_lshl_add_u32 v8, v2, 13, v48
    v_lshl_add_u32 v9, v3, 2, v2
    v_lshlrev_b32 v9, 1, v9
    s_waitcnt lgkmcnt(0)
    s_mov_b32 s4, s42
    s_mov_b32 s5, s43
    s_mov_b32 s6, 67108864
    s_mov_b32 s7, 0x00020000
    s_mov_b32 s8, s44
    s_mov_b32 s9, s45
    s_mov_b32 s10, 67108864
    s_mov_b32 s11, 0x00020000
    s_mov_b32 s12, s46
    s_mov_b32 s13, s47
    s_mov_b32 s14, 4194304
    s_mov_b32 s15, 0x00020000
    s_mov_b32 s16, s40
    s_mov_b32 s17, s41
    s_mov_b32 s18, 2048
    s_mov_b32 s19, 0x00020000
    s_mov_b32 s20, s48
    s_mov_b32 s21, s49
    s_mov_b32 s22, 268435456
    s_mov_b32 s23, 0x00020000
    s_lshl_b32 s28, s26, 5
    s_add_u32 s28, s28, s25
    s_lshl_b32 s28, s28, 20
    s_lshl_b32 s31, s52, 14
    s_add_u32 s28, s28, s31
    s_lshl_b32 s29, s24, 19
    s_lshl_b32 s31, s25, 8
    s_add_u32 s29, s29, s31
    s_lshl_b32 s30, s26, 10
    s_lshl_b32 s31, s24, 7
    s_add_u32 s30, s30, s31
    buffer_load_ushort v52, v9, s[16:19], s30 offen
    buffer_load_dwordx4 v[128:131], v8, s[12:15], s29 offen
    s_add_u32 s29, s29, 32768
    buffer_load_dwordx4 v[132:135], v8, s[12:15], s29 offen
    s_add_u32 s29, s29, 32768
    buffer_load_dwordx4 v[136:139], v8, s[12:15], s29 offen
    s_add_u32 s29, s29, 32768
    buffer_load_dwordx4 v[140:143], v8, s[12:15], s29 offen
    s_add_u32 s29, s29, 32768
    buffer_load_dwordx4 v[144:147], v8, s[12:15], s29 offen
    s_add_u32 s29, s29, 32768
    buffer_load_dwordx4 v[148:151], v8, s[12:15], s29 offen
    s_add_u32 s29, s29, 32768
    buffer_load_dwordx4 v[152:155], v8, s[12:15], s29 offen
    s_add_u32 s29, s29, 32768
    buffer_load_dwordx4 v[156:159], v8, s[12:15], s29 offen
    s_add_u32 s29, s29, 32768
    buffer_load_dwordx4 v[160:163], v8, s[12:15], s29 offen
    s_add_u32 s29, s29, 32768
    buffer_load_dwordx4 v[164:167], v8, s[12:15], s29 offen
    s_add_u32 s29, s29, 32768
    buffer_load_dwordx4 v[168:171], v8, s[12:15], s29 offen
    s_add_u32 s29, s29, 32768
    buffer_load_dwordx4 v[172:175], v8, s[12:15], s29 offen
    s_add_u32 s29, s29, 32768
    buffer_load_dwordx4 v[176:179], v8, s[12:15], s29 offen
    s_add_u32 s29, s29, 32768
    buffer_load_dwordx4 v[180:183], v8, s[12:15], s29 offen
    s_add_u32 s29, s29, 32768
    buffer_load_dwordx4 v[184:187], v8, s[12:15], s29 offen
    s_add_u32 s29, s29, 32768
    buffer_load_dwordx4 v[188:191], v8, s[12:15], s29 offen
    s_add_u32 s50, s28, 0
    buffer_load_dwordx4 v[64:67], v6, s[4:7], s50 offen offset:0 nt
    buffer_load_dwordx4 v[68:71], v6, s[4:7], s50 offen offset:1024 nt
    buffer_load_dwordx4 v[72:75], v6, s[4:7], s50 offen offset:2048 nt
    buffer_load_dwordx4 v[76:79], v6, s[4:7], s50 offen offset:3072 nt
    s_add_u32 s50, s28, 4096
    buffer_load_dwordx4 v[80:83], v6, s[4:7], s50 offen offset:0 nt
    buffer_load_dwordx4 v[84:87], v6, s[4:7], s50 offen offset:1024 nt
    buffer_load_dwordx4 v[88:91], v6, s[4:7], s50 offen offset:2048 nt
    buffer_load_dwordx4 v[92:95], v6, s[4:7], s50 offen offset:3072 nt
    s_add_u32 s50, s28, 8192
    buffer_load_dwordx4 v[96:99], v6, s[4:7], s50 offen offset:0 nt
    buffer_load_dwordx4 v[100:103], v6, s[4:7], s50 offen offset:1024 nt
    buffer_load_dwordx4 v[104:107], v6, s[4:7], s50 offen offset:2048 nt
    buffer_load_dwordx4 v[108:111], v6, s[4:7], s50 offen offset:3072 nt
    s_add_u32 s50, s28, 12288
    buffer_load_dwordx4 v[112:115], v6, s[4:7], s50 offen offset:0 nt
    buffer_load_dwordx4 v[116:119], v6, s[4:7], s50 offen offset:1024 nt
    buffer_load_dwordx4 v[120:123], v6, s[4:7], s50 offen offset:2048 nt
    buffer_load_dwordx4 v[124:127], v6, s[4:7], s50 offen offset:3072 nt
    v_mov_b32 v24, 0
    v_mov_b32 v25, 0
    v_mov_b32 v26, 0
    v_mov_b32 v27, 0
    s_waitcnt vmcnt(32)
    v_lshl_or_b32 v52, v52, 16, v52
    s_waitcnt vmcnt(31)
    s_nop 0
    v_and_b32_dpp v28, v52, v10 row_newbcast:0 row_mask:0xf bank_mask:0xf
    v_and_b32_dpp v29, v52, v11 row_newbcast:0 row_mask:0xf bank_mask:0xf
    v_and_b32_dpp v30, v52, v12 row_newbcast:0 row_mask:0xf bank_mask:0xf
    v_and_b32_dpp v31, v52, v13 row_newbcast:0 row_mask:0xf bank_mask:0xf
    s_nop 1
    v_mfma_f32_16x16x32_bf16 v[24:27], v[28:31], v[128:131], v[24:27]
    s_waitcnt vmcnt(30)
    v_and_b32_dpp v28, v52, v10 row_newbcast:1 row_mask:0xf bank_mask:0xf
    v_and_b32_dpp v29, v52, v11 row_newbcast:1 row_mask:0xf bank_mask:0xf
    v_and_b32_dpp v30, v52, v12 row_newbcast:1 row_mask:0xf bank_mask:0xf
    v_and_b32_dpp v31, v52, v13 row_newbcast:1 row_mask:0xf bank_mask:0xf
    s_nop 1
    v_mfma_f32_16x16x32_bf16 v[24:27], v[28:31], v[132:135], v[24:27]
    s_waitcnt vmcnt(29)
    v_and_b32_dpp v28, v52, v10 row_newbcast:2 row_mask:0xf bank_mask:0xf
    v_and_b32_dpp v29, v52, v11 row_newbcast:2 row_mask:0xf bank_mask:0xf
    v_and_b32_dpp v30, v52, v12 row_newbcast:2 row_mask:0xf bank_mask:0xf
    v_and_b32_dpp v31, v52, v13 row_newbcast:2 row_mask:0xf bank_mask:0xf
    s_nop 1
    v_mfma_f32_16x16x32_bf16 v[24:27], v[28:31], v[136:139], v[24:27]
    s_waitcnt vmcnt(28)
    v_and_b32_dpp v28, v52, v10 row_newbcast:3 row_mask:0xf bank_mask:0xf
    v_and_b32_dpp v29, v52, v11 row_newbcast:3 row_mask:0xf bank_mask:0xf
    v_and_b32_dpp v30, v52, v12 row_newbcast:3 row_mask:0xf bank_mask:0xf
    v_and_b32_dpp v31, v52, v13 row_newbcast:3 row_mask:0xf bank_mask:0xf
    s_nop 1
    v_mfma_f32_16x16x32_bf16 v[24:27], v[28:31], v[140:143], v[24:27]
    s_waitcnt vmcnt(27)
    v_and_b32_dpp v28, v52, v10 row_newbcast:4 row_mask:0xf bank_mask:0xf
    v_and_b32_dpp v29, v52, v11 row_newbcast:4 row_mask:0xf bank_mask:0xf
    v_and_b32_dpp v30, v52, v12 row_newbcast:4 row_mask:0xf bank_mask:0xf
    v_and_b32_dpp v31, v52, v13 row_newbcast:4 row_mask:0xf bank_mask:0xf
    s_nop 1
    v_mfma_f32_16x16x32_bf16 v[24:27], v[28:31], v[144:147], v[24:27]
    s_waitcnt vmcnt(26)
    v_and_b32_dpp v28, v52, v10 row_newbcast:5 row_mask:0xf bank_mask:0xf
    v_and_b32_dpp v29, v52, v11 row_newbcast:5 row_mask:0xf bank_mask:0xf
    v_and_b32_dpp v30, v52, v12 row_newbcast:5 row_mask:0xf bank_mask:0xf
    v_and_b32_dpp v31, v52, v13 row_newbcast:5 row_mask:0xf bank_mask:0xf
    s_nop 1
    v_mfma_f32_16x16x32_bf16 v[24:27], v[28:31], v[148:151], v[24:27]
    s_waitcnt vmcnt(25)
    v_and_b32_dpp v28, v52, v10 row_newbcast:6 row_mask:0xf bank_mask:0xf
    v_and_b32_dpp v29, v52, v11 row_newbcast:6 row_mask:0xf bank_mask:0xf
    v_and_b32_dpp v30, v52, v12 row_newbcast:6 row_mask:0xf bank_mask:0xf
    v_and_b32_dpp v31, v52, v13 row_newbcast:6 row_mask:0xf bank_mask:0xf
    s_nop 1
    v_mfma_f32_16x16x32_bf16 v[24:27], v[28:31], v[152:155], v[24:27]
    s_waitcnt vmcnt(24)
    v_and_b32_dpp v28, v52, v10 row_newbcast:7 row_mask:0xf bank_mask:0xf
    v_and_b32_dpp v29, v52, v11 row_newbcast:7 row_mask:0xf bank_mask:0xf
    v_and_b32_dpp v30, v52, v12 row_newbcast:7 row_mask:0xf bank_mask:0xf
    v_and_b32_dpp v31, v52, v13 row_newbcast:7 row_mask:0xf bank_mask:0xf
    s_nop 1
    v_mfma_f32_16x16x32_bf16 v[24:27], v[28:31], v[156:159], v[24:27]
    s_waitcnt vmcnt(23)
    v_and_b32_dpp v28, v52, v10 row_newbcast:8 row_mask:0xf bank_mask:0xf
    v_and_b32_dpp v29, v52, v11 row_newbcast:8 row_mask:0xf bank_mask:0xf
    v_and_b32_dpp v30, v52, v12 row_newbcast:8 row_mask:0xf bank_mask:0xf
    v_and_b32_dpp v31, v52, v13 row_newbcast:8 row_mask:0xf bank_mask:0xf
    s_nop 1
    v_mfma_f32_16x16x32_bf16 v[24:27], v[28:31], v[160:163], v[24:27]
    s_waitcnt vmcnt(22)
    v_and_b32_dpp v28, v52, v10 row_newbcast:9 row_mask:0xf bank_mask:0xf
    v_and_b32_dpp v29, v52, v11 row_newbcast:9 row_mask:0xf bank_mask:0xf
    v_and_b32_dpp v30, v52, v12 row_newbcast:9 row_mask:0xf bank_mask:0xf
    v_and_b32_dpp v31, v52, v13 row_newbcast:9 row_mask:0xf bank_mask:0xf
    s_nop 1
    v_mfma_f32_16x16x32_bf16 v[24:27], v[28:31], v[164:167], v[24:27]
    s_waitcnt vmcnt(21)
    v_and_b32_dpp v28, v52, v10 row_newbcast:10 row_mask:0xf bank_mask:0xf
    v_and_b32_dpp v29, v52, v11 row_newbcast:10 row_mask:0xf bank_mask:0xf
    v_and_b32_dpp v30, v52, v12 row_newbcast:10 row_mask:0xf bank_mask:0xf
    v_and_b32_dpp v31, v52, v13 row_newbcast:10 row_mask:0xf bank_mask:0xf
    s_nop 1
    v_mfma_f32_16x16x32_bf16 v[24:27], v[28:31], v[168:171], v[24:27]
    s_waitcnt vmcnt(20)
    v_and_b32_dpp v28, v52, v10 row_newbcast:11 row_mask:0xf bank_mask:0xf
    v_and_b32_dpp v29, v52, v11 row_newbcast:11 row_mask:0xf bank_mask:0xf
    v_and_b32_dpp v30, v52, v12 row_newbcast:11 row_mask:0xf bank_mask:0xf
    v_and_b32_dpp v31, v52, v13 row_newbcast:11 row_mask:0xf bank_mask:0xf
    s_nop 1
    v_mfma_f32_16x16x32_bf16 v[24:27], v[28:31], v[172:175], v[24:27]
    s_waitcnt vmcnt(19)
    v_and_b32_dpp v28, v52, v10 row_newbcast:12 row_mask:0xf bank_mask:0xf
    v_and_b32_dpp v29, v52, v11 row_newbcast:12 row_mask:0xf bank_mask:0xf
    v_and_b32_dpp v30, v52, v12 row_newbcast:12 row_mask:0xf bank_mask:0xf
    v_and_b32_dpp v31, v52, v13 row_newbcast:12 row_mask:0xf bank_mask:0xf
    s_nop 1
    v_mfma_f32_16x16x32_bf16 v[24:27], v[28:31], v[176:179], v[24:27]
    s_waitcnt vmcnt(18)
    v_and_b32_dpp v28, v52, v10 row_newbcast:13 row_mask:0xf bank_mask:0xf
    v_and_b32_dpp v29, v52, v11 row_newbcast:13 row_mask:0xf bank_mask:0xf
    v_and_b32_dpp v30, v52, v12 row_newbcast:13 row_mask:0xf bank_mask:0xf
    v_and_b32_dpp v31, v52, v13 row_newbcast:13 row_mask:0xf bank_mask:0xf
    s_nop 1
    v_mfma_f32_16x16x32_bf16 v[24:27], v[28:31], v[180:183], v[24:27]
    s_waitcnt vmcnt(17)
    v_and_b32_dpp v28, v52, v10 row_newbcast:14 row_mask:0xf bank_mask:0xf
    v_and_b32_dpp v29, v52, v11 row_newbcast:14 row_mask:0xf bank_mask:0xf
    v_and_b32_dpp v30, v52, v12 row_newbcast:14 row_mask:0xf bank_mask:0xf
    v_and_b32_dpp v31, v52, v13 row_newbcast:14 row_mask:0xf bank_mask:0xf
    s_nop 1
    v_mfma_f32_16x16x32_bf16 v[24:27], v[28:31], v[184:187], v[24:27]
    s_waitcnt vmcnt(16)
    v_and_b32_dpp v28, v52, v10 row_newbcast:15 row_mask:0xf bank_mask:0xf
    v_and_b32_dpp v29, v52, v11 row_newbcast:15 row_mask:0xf bank_mask:0xf
    v_and_b32_dpp v30, v52, v12 row_newbcast:15 row_mask:0xf bank_mask:0xf
    v_and_b32_dpp v31, v52, v13 row_newbcast:15 row_mask:0xf bank_mask:0xf
    s_nop 1
    v_mfma_f32_16x16x32_bf16 v[24:27], v[28:31], v[188:191], v[24:27]
    v_lshlrev_b32 v48, 5, v3
    v_lshl_add_u32 v48, v2, 4, v48
    s_lshl_b32 s31, s24, 9
    v_add_u32 v49, s31, v48
    s_mov_b32 exec_lo, -1
    s_mov_b32 exec_hi, 0
    s_nop 1
    ds_write_b128 v49, v[24:27] offset:0
    s_mov_b64 exec, -1
    s_waitcnt lgkmcnt(0)
    s_barrier
    s_mov_b32 exec_lo, -1
    s_mov_b32 exec_hi, 0
    ds_read_b128 v[128:131], v48 offset:0
    ds_read_b128 v[132:135], v48 offset:512
    ds_read_b128 v[136:139], v48 offset:1024
    ds_read_b128 v[140:143], v48 offset:1536
    ds_read_b128 v[144:147], v48 offset:2048
    ds_read_b128 v[148:151], v48 offset:2560
    ds_read_b128 v[152:155], v48 offset:3072
    ds_read_b128 v[156:159], v48 offset:3584
    s_waitcnt lgkmcnt(0)
    v_add_f32 v128, v128, v132
    v_add_f32 v129, v129, v133
    v_add_f32 v130, v130, v134
    v_add_f32 v131, v131, v135
    v_add_f32 v128, v128, v136
    v_add_f32 v129, v129, v137
    v_add_f32 v130, v130, v138
    v_add_f32 v131, v131, v139
    v_add_f32 v128, v128, v140
    v_add_f32 v129, v129, v141
    v_add_f32 v130, v130, v142
    v_add_f32 v131, v131, v143
    v_add_f32 v128, v128, v144
    v_add_f32 v129, v129, v145
    v_add_f32 v130, v130, v146
    v_add_f32 v131, v131, v147
    v_add_f32 v128, v128, v148
    v_add_f32 v129, v129, v149
    v_add_f32 v130, v130, v150
    v_add_f32 v131, v131, v151
    v_add_f32 v128, v128, v152
    v_add_f32 v129, v129, v153
    v_add_f32 v130, v130, v154
    v_add_f32 v131, v131, v155
    v_add_f32 v128, v128, v156
    v_add_f32 v129, v129, v157
    v_add_f32 v130, v130, v158
    v_add_f32 v131, v131, v159
    v_cvt_pk_bf16_f32 v128, v128, v129
    v_cvt_pk_bf16_f32 v129, v130, v131
    v_lshrrev_b32 v48, 1, v48
    s_lshl_b32 s31, s24, 8
    v_add_u32 v48, s31, v48
    ds_write_b64 v48, v[128:129] offset:4096
    s_mov_b64 exec, -1
    v_lshlrev_b32 v49, 6, v2
    v_lshl_add_u32 v49, v5, 4, v49
    v_add_u32 v49, s31, v49
    s_waitcnt lgkmcnt(0)
    ds_read_b128 v[14:17], v49 offset:4096
    s_waitcnt lgkmcnt(0)
    s_waitcnt vmcnt(15)
    v_dot2_f32_bf16 v32, v64, v14, 0
    v_dot2c_f32_bf16 v32, v65, v15
    v_dot2c_f32_bf16 v32, v66, v16
    v_dot2c_f32_bf16 v32, v67, v17
    s_add_u32 s50, s28, 131072
    buffer_load_dwordx4 v[64:67], v6, s[4:7], s50 offen offset:0 nt
    s_waitcnt vmcnt(15)
    v_dot2_f32_bf16 v33, v68, v14, 0
    v_dot2c_f32_bf16 v33, v69, v15
    v_dot2c_f32_bf16 v33, v70, v16
    v_dot2c_f32_bf16 v33, v71, v17
    buffer_load_dwordx4 v[68:71], v6, s[4:7], s50 offen offset:1024 nt
    s_waitcnt vmcnt(15)
    v_dot2_f32_bf16 v34, v72, v14, 0
    v_dot2c_f32_bf16 v34, v73, v15
    v_dot2c_f32_bf16 v34, v74, v16
    v_dot2c_f32_bf16 v34, v75, v17
    buffer_load_dwordx4 v[72:75], v6, s[4:7], s50 offen offset:2048 nt
    s_waitcnt vmcnt(15)
    v_dot2_f32_bf16 v35, v76, v14, 0
    v_dot2c_f32_bf16 v35, v77, v15
    v_dot2c_f32_bf16 v35, v78, v16
    v_dot2c_f32_bf16 v35, v79, v17
    buffer_load_dwordx4 v[76:79], v6, s[4:7], s50 offen offset:3072 nt
    s_waitcnt vmcnt(15)
    v_dot2_f32_bf16 v36, v80, v14, 0
    v_dot2c_f32_bf16 v36, v81, v15
    v_dot2c_f32_bf16 v36, v82, v16
    v_dot2c_f32_bf16 v36, v83, v17
    s_add_u32 s50, s28, 135168
    buffer_load_dwordx4 v[80:83], v6, s[4:7], s50 offen offset:0 nt
    s_waitcnt vmcnt(15)
    v_dot2_f32_bf16 v37, v84, v14, 0
    v_dot2c_f32_bf16 v37, v85, v15
    v_dot2c_f32_bf16 v37, v86, v16
    v_dot2c_f32_bf16 v37, v87, v17
    buffer_load_dwordx4 v[84:87], v6, s[4:7], s50 offen offset:1024 nt
    s_waitcnt vmcnt(15)
    v_dot2_f32_bf16 v38, v88, v14, 0
    v_dot2c_f32_bf16 v38, v89, v15
    v_dot2c_f32_bf16 v38, v90, v16
    v_dot2c_f32_bf16 v38, v91, v17
    buffer_load_dwordx4 v[88:91], v6, s[4:7], s50 offen offset:2048 nt
    s_waitcnt vmcnt(15)
    v_dot2_f32_bf16 v39, v92, v14, 0
    v_dot2c_f32_bf16 v39, v93, v15
    v_dot2c_f32_bf16 v39, v94, v16
    v_dot2c_f32_bf16 v39, v95, v17
    buffer_load_dwordx4 v[92:95], v6, s[4:7], s50 offen offset:3072 nt
    s_waitcnt vmcnt(15)
    v_dot2_f32_bf16 v40, v96, v14, 0
    v_dot2c_f32_bf16 v40, v97, v15
    v_dot2c_f32_bf16 v40, v98, v16
    v_dot2c_f32_bf16 v40, v99, v17
    s_add_u32 s50, s28, 139264
    buffer_load_dwordx4 v[96:99], v6, s[4:7], s50 offen offset:0 nt
    s_waitcnt vmcnt(15)
    v_dot2_f32_bf16 v41, v100, v14, 0
    v_dot2c_f32_bf16 v41, v101, v15
    v_dot2c_f32_bf16 v41, v102, v16
    v_dot2c_f32_bf16 v41, v103, v17
    buffer_load_dwordx4 v[100:103], v6, s[4:7], s50 offen offset:1024 nt
    s_waitcnt vmcnt(15)
    v_dot2_f32_bf16 v42, v104, v14, 0
    v_dot2c_f32_bf16 v42, v105, v15
    v_dot2c_f32_bf16 v42, v106, v16
    v_dot2c_f32_bf16 v42, v107, v17
    buffer_load_dwordx4 v[104:107], v6, s[4:7], s50 offen offset:2048 nt
    s_waitcnt vmcnt(15)
    v_dot2_f32_bf16 v43, v108, v14, 0
    v_dot2c_f32_bf16 v43, v109, v15
    v_dot2c_f32_bf16 v43, v110, v16
    v_dot2c_f32_bf16 v43, v111, v17
    buffer_load_dwordx4 v[108:111], v6, s[4:7], s50 offen offset:3072 nt
    s_waitcnt vmcnt(15)
    v_dot2_f32_bf16 v44, v112, v14, 0
    v_dot2c_f32_bf16 v44, v113, v15
    v_dot2c_f32_bf16 v44, v114, v16
    v_dot2c_f32_bf16 v44, v115, v17
    s_add_u32 s50, s28, 143360
    buffer_load_dwordx4 v[112:115], v6, s[4:7], s50 offen offset:0 nt
    s_waitcnt vmcnt(15)
    v_dot2_f32_bf16 v45, v116, v14, 0
    v_dot2c_f32_bf16 v45, v117, v15
    v_dot2c_f32_bf16 v45, v118, v16
    v_dot2c_f32_bf16 v45, v119, v17
    buffer_load_dwordx4 v[116:119], v6, s[4:7], s50 offen offset:1024 nt
    s_waitcnt vmcnt(15)
    v_dot2_f32_bf16 v46, v120, v14, 0
    v_dot2c_f32_bf16 v46, v121, v15
    v_dot2c_f32_bf16 v46, v122, v16
    v_dot2c_f32_bf16 v46, v123, v17
    buffer_load_dwordx4 v[120:123], v6, s[4:7], s50 offen offset:2048 nt
    s_waitcnt vmcnt(15)
    v_dot2_f32_bf16 v47, v124, v14, 0
    v_dot2c_f32_bf16 v47, v125, v15
    v_dot2c_f32_bf16 v47, v126, v16
    v_dot2c_f32_bf16 v47, v127, v17
    buffer_load_dwordx4 v[124:127], v6, s[4:7], s50 offen offset:3072 nt
    v_permlane32_swap_b32 v32, v40
    v_add_f32 v32, v32, v40
    v_permlane32_swap_b32 v33, v41
    v_add_f32 v33, v33, v41
    v_permlane32_swap_b32 v34, v42
    v_add_f32 v34, v34, v42
    v_permlane32_swap_b32 v35, v43
    v_add_f32 v35, v35, v43
    v_permlane32_swap_b32 v36, v44
    v_add_f32 v36, v36, v44
    v_permlane32_swap_b32 v37, v45
    v_add_f32 v37, v37, v45
    v_permlane32_swap_b32 v38, v46
    v_add_f32 v38, v38, v46
    v_permlane32_swap_b32 v39, v47
    v_add_f32 v39, v39, v47
    v_permlane16_swap_b32 v32, v36
    v_add_f32 v32, v32, v36
    v_permlane16_swap_b32 v33, v37
    v_add_f32 v33, v33, v37
    v_permlane16_swap_b32 v34, v38
    v_add_f32 v34, v34, v38
    v_permlane16_swap_b32 v35, v39
    v_add_f32 v35, v35, v39
    v_cndmask_b32 v48, v32, v34, s[32:33]
    v_cndmask_b32 v49, v34, v32, s[32:33]
    s_nop 1
    v_add_f32_dpp v32, v49, v48 quad_perm:[2,3,0,1] row_mask:0xf bank_mask:0xf
    v_cndmask_b32 v48, v33, v35, s[32:33]
    v_cndmask_b32 v49, v35, v33, s[32:33]
    s_nop 1
    v_add_f32_dpp v33, v49, v48 quad_perm:[2,3,0,1] row_mask:0xf bank_mask:0xf
    v_cndmask_b32 v48, v32, v33, s[34:35]
    v_cndmask_b32 v49, v33, v32, s[34:35]
    s_nop 1
    v_add_f32_dpp v18, v49, v48 quad_perm:[1,0,3,2] row_mask:0xf bank_mask:0xf
    s_waitcnt vmcnt(15)
    v_dot2_f32_bf16 v32, v64, v14, 0
    v_dot2c_f32_bf16 v32, v65, v15
    v_dot2c_f32_bf16 v32, v66, v16
    v_dot2c_f32_bf16 v32, v67, v17
    s_add_u32 s50, s28, 262144
    buffer_load_dwordx4 v[64:67], v6, s[4:7], s50 offen offset:0 nt
    s_waitcnt vmcnt(15)
    v_dot2_f32_bf16 v33, v68, v14, 0
    v_dot2c_f32_bf16 v33, v69, v15
    v_dot2c_f32_bf16 v33, v70, v16
    v_dot2c_f32_bf16 v33, v71, v17
    buffer_load_dwordx4 v[68:71], v6, s[4:7], s50 offen offset:1024 nt
    s_waitcnt vmcnt(15)
    v_dot2_f32_bf16 v34, v72, v14, 0
    v_dot2c_f32_bf16 v34, v73, v15
    v_dot2c_f32_bf16 v34, v74, v16
    v_dot2c_f32_bf16 v34, v75, v17
    buffer_load_dwordx4 v[72:75], v6, s[4:7], s50 offen offset:2048 nt
    s_waitcnt vmcnt(15)
    v_dot2_f32_bf16 v35, v76, v14, 0
    v_dot2c_f32_bf16 v35, v77, v15
    v_dot2c_f32_bf16 v35, v78, v16
    v_dot2c_f32_bf16 v35, v79, v17
    buffer_load_dwordx4 v[76:79], v6, s[4:7], s50 offen offset:3072 nt
    s_waitcnt vmcnt(15)
    v_dot2_f32_bf16 v36, v80, v14, 0
    v_dot2c_f32_bf16 v36, v81, v15
    v_dot2c_f32_bf16 v36, v82, v16
    v_dot2c_f32_bf16 v36, v83, v17
    s_add_u32 s50, s28, 266240
    buffer_load_dwordx4 v[80:83], v6, s[4:7], s50 offen offset:0 nt
    s_waitcnt vmcnt(15)
    v_dot2_f32_bf16 v37, v84, v14, 0
    v_dot2c_f32_bf16 v37, v85, v15
    v_dot2c_f32_bf16 v37, v86, v16
    v_dot2c_f32_bf16 v37, v87, v17
    buffer_load_dwordx4 v[84:87], v6, s[4:7], s50 offen offset:1024 nt
    s_waitcnt vmcnt(15)
    v_dot2_f32_bf16 v38, v88, v14, 0
    v_dot2c_f32_bf16 v38, v89, v15
    v_dot2c_f32_bf16 v38, v90, v16
    v_dot2c_f32_bf16 v38, v91, v17
    buffer_load_dwordx4 v[88:91], v6, s[4:7], s50 offen offset:2048 nt
    s_waitcnt vmcnt(15)
    v_dot2_f32_bf16 v39, v92, v14, 0
    v_dot2c_f32_bf16 v39, v93, v15
    v_dot2c_f32_bf16 v39, v94, v16
    v_dot2c_f32_bf16 v39, v95, v17
    buffer_load_dwordx4 v[92:95], v6, s[4:7], s50 offen offset:3072 nt
    s_waitcnt vmcnt(15)
    v_dot2_f32_bf16 v40, v96, v14, 0
    v_dot2c_f32_bf16 v40, v97, v15
    v_dot2c_f32_bf16 v40, v98, v16
    v_dot2c_f32_bf16 v40, v99, v17
    s_add_u32 s50, s28, 270336
    buffer_load_dwordx4 v[96:99], v6, s[4:7], s50 offen offset:0 nt
    s_waitcnt vmcnt(15)
    v_dot2_f32_bf16 v41, v100, v14, 0
    v_dot2c_f32_bf16 v41, v101, v15
    v_dot2c_f32_bf16 v41, v102, v16
    v_dot2c_f32_bf16 v41, v103, v17
    buffer_load_dwordx4 v[100:103], v6, s[4:7], s50 offen offset:1024 nt
    s_waitcnt vmcnt(15)
    v_dot2_f32_bf16 v42, v104, v14, 0
    v_dot2c_f32_bf16 v42, v105, v15
    v_dot2c_f32_bf16 v42, v106, v16
    v_dot2c_f32_bf16 v42, v107, v17
    buffer_load_dwordx4 v[104:107], v6, s[4:7], s50 offen offset:2048 nt
    s_waitcnt vmcnt(15)
    v_dot2_f32_bf16 v43, v108, v14, 0
    v_dot2c_f32_bf16 v43, v109, v15
    v_dot2c_f32_bf16 v43, v110, v16
    v_dot2c_f32_bf16 v43, v111, v17
    buffer_load_dwordx4 v[108:111], v6, s[4:7], s50 offen offset:3072 nt
    s_waitcnt vmcnt(15)
    v_dot2_f32_bf16 v44, v112, v14, 0
    v_dot2c_f32_bf16 v44, v113, v15
    v_dot2c_f32_bf16 v44, v114, v16
    v_dot2c_f32_bf16 v44, v115, v17
    s_add_u32 s50, s28, 274432
    buffer_load_dwordx4 v[112:115], v6, s[4:7], s50 offen offset:0 nt
    s_waitcnt vmcnt(15)
    v_dot2_f32_bf16 v45, v116, v14, 0
    v_dot2c_f32_bf16 v45, v117, v15
    v_dot2c_f32_bf16 v45, v118, v16
    v_dot2c_f32_bf16 v45, v119, v17
    buffer_load_dwordx4 v[116:119], v6, s[4:7], s50 offen offset:1024 nt
    s_waitcnt vmcnt(15)
    v_dot2_f32_bf16 v46, v120, v14, 0
    v_dot2c_f32_bf16 v46, v121, v15
    v_dot2c_f32_bf16 v46, v122, v16
    v_dot2c_f32_bf16 v46, v123, v17
    buffer_load_dwordx4 v[120:123], v6, s[4:7], s50 offen offset:2048 nt
    s_waitcnt vmcnt(15)
    v_dot2_f32_bf16 v47, v124, v14, 0
    v_dot2c_f32_bf16 v47, v125, v15
    v_dot2c_f32_bf16 v47, v126, v16
    v_dot2c_f32_bf16 v47, v127, v17
    buffer_load_dwordx4 v[124:127], v6, s[4:7], s50 offen offset:3072 nt
    v_permlane32_swap_b32 v32, v40
    v_add_f32 v32, v32, v40
    v_permlane32_swap_b32 v33, v41
    v_add_f32 v33, v33, v41
    v_permlane32_swap_b32 v34, v42
    v_add_f32 v34, v34, v42
    v_permlane32_swap_b32 v35, v43
    v_add_f32 v35, v35, v43
    v_permlane32_swap_b32 v36, v44
    v_add_f32 v36, v36, v44
    v_permlane32_swap_b32 v37, v45
    v_add_f32 v37, v37, v45
    v_permlane32_swap_b32 v38, v46
    v_add_f32 v38, v38, v46
    v_permlane32_swap_b32 v39, v47
    v_add_f32 v39, v39, v47
    v_permlane16_swap_b32 v32, v36
    v_add_f32 v32, v32, v36
    v_permlane16_swap_b32 v33, v37
    v_add_f32 v33, v33, v37
    v_permlane16_swap_b32 v34, v38
    v_add_f32 v34, v34, v38
    v_permlane16_swap_b32 v35, v39
    v_add_f32 v35, v35, v39
    v_cndmask_b32 v48, v32, v34, s[32:33]
    v_cndmask_b32 v49, v34, v32, s[32:33]
    s_nop 1
    v_add_f32_dpp v32, v49, v48 quad_perm:[2,3,0,1] row_mask:0xf bank_mask:0xf
    v_cndmask_b32 v48, v33, v35, s[32:33]
    v_cndmask_b32 v49, v35, v33, s[32:33]
    s_nop 1
    v_add_f32_dpp v33, v49, v48 quad_perm:[2,3,0,1] row_mask:0xf bank_mask:0xf
    v_cndmask_b32 v48, v32, v33, s[34:35]
    v_cndmask_b32 v49, v33, v32, s[34:35]
    s_nop 1
    v_add_f32_dpp v19, v49, v48 quad_perm:[1,0,3,2] row_mask:0xf bank_mask:0xf
    s_waitcnt vmcnt(15)
    v_dot2_f32_bf16 v32, v64, v14, 0
    v_dot2c_f32_bf16 v32, v65, v15
    v_dot2c_f32_bf16 v32, v66, v16
    v_dot2c_f32_bf16 v32, v67, v17
    s_add_u32 s51, s28, 0
    buffer_load_dwordx4 v[64:67], v7, s[8:11], s51 offen offset:0 nt
    s_waitcnt vmcnt(15)
    v_dot2_f32_bf16 v33, v68, v14, 0
    v_dot2c_f32_bf16 v33, v69, v15
    v_dot2c_f32_bf16 v33, v70, v16
    v_dot2c_f32_bf16 v33, v71, v17
    buffer_load_dwordx4 v[68:71], v7, s[8:11], s51 offen offset:1024 nt
    s_waitcnt vmcnt(15)
    v_dot2_f32_bf16 v34, v72, v14, 0
    v_dot2c_f32_bf16 v34, v73, v15
    v_dot2c_f32_bf16 v34, v74, v16
    v_dot2c_f32_bf16 v34, v75, v17
    buffer_load_dwordx4 v[72:75], v7, s[8:11], s51 offen offset:2048 nt
    s_waitcnt vmcnt(15)
    v_dot2_f32_bf16 v35, v76, v14, 0
    v_dot2c_f32_bf16 v35, v77, v15
    v_dot2c_f32_bf16 v35, v78, v16
    v_dot2c_f32_bf16 v35, v79, v17
    buffer_load_dwordx4 v[76:79], v7, s[8:11], s51 offen offset:3072 nt
    s_waitcnt vmcnt(15)
    v_dot2_f32_bf16 v36, v80, v14, 0
    v_dot2c_f32_bf16 v36, v81, v15
    v_dot2c_f32_bf16 v36, v82, v16
    v_dot2c_f32_bf16 v36, v83, v17
    buffer_load_dwordx4 v[80:83], v7, s[8:11], s51 offen offset:256 nt
    s_waitcnt vmcnt(15)
    v_dot2_f32_bf16 v37, v84, v14, 0
    v_dot2c_f32_bf16 v37, v85, v15
    v_dot2c_f32_bf16 v37, v86, v16
    v_dot2c_f32_bf16 v37, v87, v17
    buffer_load_dwordx4 v[84:87], v7, s[8:11], s51 offen offset:1280 nt
    s_waitcnt vmcnt(15)
    v_dot2_f32_bf16 v38, v88, v14, 0
    v_dot2c_f32_bf16 v38, v89, v15
    v_dot2c_f32_bf16 v38, v90, v16
    v_dot2c_f32_bf16 v38, v91, v17
    buffer_load_dwordx4 v[88:91], v7, s[8:11], s51 offen offset:2304 nt
    s_waitcnt vmcnt(15)
    v_dot2_f32_bf16 v39, v92, v14, 0
    v_dot2c_f32_bf16 v39, v93, v15
    v_dot2c_f32_bf16 v39, v94, v16
    v_dot2c_f32_bf16 v39, v95, v17
    buffer_load_dwordx4 v[92:95], v7, s[8:11], s51 offen offset:3328 nt
    s_waitcnt vmcnt(15)
    v_dot2_f32_bf16 v40, v96, v14, 0
    v_dot2c_f32_bf16 v40, v97, v15
    v_dot2c_f32_bf16 v40, v98, v16
    v_dot2c_f32_bf16 v40, v99, v17
    buffer_load_dwordx4 v[96:99], v7, s[8:11], s51 offen offset:512 nt
    s_waitcnt vmcnt(15)
    v_dot2_f32_bf16 v41, v100, v14, 0
    v_dot2c_f32_bf16 v41, v101, v15
    v_dot2c_f32_bf16 v41, v102, v16
    v_dot2c_f32_bf16 v41, v103, v17
    buffer_load_dwordx4 v[100:103], v7, s[8:11], s51 offen offset:1536 nt
    s_waitcnt vmcnt(15)
    v_dot2_f32_bf16 v42, v104, v14, 0
    v_dot2c_f32_bf16 v42, v105, v15
    v_dot2c_f32_bf16 v42, v106, v16
    v_dot2c_f32_bf16 v42, v107, v17
    buffer_load_dwordx4 v[104:107], v7, s[8:11], s51 offen offset:2560 nt
    s_waitcnt vmcnt(15)
    v_dot2_f32_bf16 v43, v108, v14, 0
    v_dot2c_f32_bf16 v43, v109, v15
    v_dot2c_f32_bf16 v43, v110, v16
    v_dot2c_f32_bf16 v43, v111, v17
    buffer_load_dwordx4 v[108:111], v7, s[8:11], s51 offen offset:3584 nt
    s_waitcnt vmcnt(15)
    v_dot2_f32_bf16 v44, v112, v14, 0
    v_dot2c_f32_bf16 v44, v113, v15
    v_dot2c_f32_bf16 v44, v114, v16
    v_dot2c_f32_bf16 v44, v115, v17
    buffer_load_dwordx4 v[112:115], v7, s[8:11], s51 offen offset:768 nt
    s_waitcnt vmcnt(15)
    v_dot2_f32_bf16 v45, v116, v14, 0
    v_dot2c_f32_bf16 v45, v117, v15
    v_dot2c_f32_bf16 v45, v118, v16
    v_dot2c_f32_bf16 v45, v119, v17
    buffer_load_dwordx4 v[116:119], v7, s[8:11], s51 offen offset:1792 nt
    s_waitcnt vmcnt(15)
    v_dot2_f32_bf16 v46, v120, v14, 0
    v_dot2c_f32_bf16 v46, v121, v15
    v_dot2c_f32_bf16 v46, v122, v16
    v_dot2c_f32_bf16 v46, v123, v17
    buffer_load_dwordx4 v[120:123], v7, s[8:11], s51 offen offset:2816 nt
    s_waitcnt vmcnt(15)
    v_dot2_f32_bf16 v47, v124, v14, 0
    v_dot2c_f32_bf16 v47, v125, v15
    v_dot2c_f32_bf16 v47, v126, v16
    v_dot2c_f32_bf16 v47, v127, v17
    buffer_load_dwordx4 v[124:127], v7, s[8:11], s51 offen offset:3840 nt
    v_permlane32_swap_b32 v32, v40
    v_add_f32 v32, v32, v40
    v_permlane32_swap_b32 v33, v41
    v_add_f32 v33, v33, v41
    v_permlane32_swap_b32 v34, v42
    v_add_f32 v34, v34, v42
    v_permlane32_swap_b32 v35, v43
    v_add_f32 v35, v35, v43
    v_permlane32_swap_b32 v36, v44
    v_add_f32 v36, v36, v44
    v_permlane32_swap_b32 v37, v45
    v_add_f32 v37, v37, v45
    v_permlane32_swap_b32 v38, v46
    v_add_f32 v38, v38, v46
    v_permlane32_swap_b32 v39, v47
    v_add_f32 v39, v39, v47
    v_permlane16_swap_b32 v32, v36
    v_add_f32 v32, v32, v36
    v_permlane16_swap_b32 v33, v37
    v_add_f32 v33, v33, v37
    v_permlane16_swap_b32 v34, v38
    v_add_f32 v34, v34, v38
    v_permlane16_swap_b32 v35, v39
    v_add_f32 v35, v35, v39
    v_cndmask_b32 v48, v32, v34, s[32:33]
    v_cndmask_b32 v49, v34, v32, s[32:33]
    s_nop 1
    v_add_f32_dpp v32, v49, v48 quad_perm:[2,3,0,1] row_mask:0xf bank_mask:0xf
    v_cndmask_b32 v48, v33, v35, s[32:33]
    v_cndmask_b32 v49, v35, v33, s[32:33]
    s_nop 1
    v_add_f32_dpp v33, v49, v48 quad_perm:[2,3,0,1] row_mask:0xf bank_mask:0xf
    v_cndmask_b32 v48, v32, v33, s[34:35]
    v_cndmask_b32 v49, v33, v32, s[34:35]
    s_nop 1
    v_add_f32_dpp v54, v49, v48 quad_perm:[1,0,3,2] row_mask:0xf bank_mask:0xf
    v_max_f32 v23, v18, v19
    v_max_f32 v23, v23, v54
    s_nop 1
    v_max_f32_dpp v23, v23, v23 row_ror:8 row_mask:0xf bank_mask:0xf
    s_nop 1
    v_max_f32_dpp v23, v23, v23 row_ror:4 row_mask:0xf bank_mask:0xf
    s_nop 1
    v_max_f32_dpp v23, v23, v23 row_ror:2 row_mask:0xf bank_mask:0xf
    s_nop 1
    v_max_f32_dpp v23, v23, v23 row_ror:1 row_mask:0xf bank_mask:0xf
    v_mov_b32 v48, v23
    v_mov_b32 v49, v23
    s_nop 1
    v_permlane16_swap_b32 v48, v49
    v_max_f32 v23, v48, v49
    v_mov_b32 v48, v23
    v_mov_b32 v49, v23
    s_nop 1
    v_permlane32_swap_b32 v48, v49
    v_max_f32 v23, v48, v49
    s_mov_b32 s36, 0x3e0293ee
    v_mul_f32 v23, s36, v23
    v_fma_f32 v18, v18, s36, -v23
    v_fma_f32 v19, v19, s36, -v23
    v_fma_f32 v54, v54, s36, -v23
    v_exp_f32 v18, v18
    v_exp_f32 v19, v19
    v_exp_f32 v54, v54
    v_cvt_pk_bf16_f32 v20, v18, v18
    v_cvt_pk_bf16_f32 v21, v19, v19
    v_cvt_pk_bf16_f32 v55, v54, v54
    v_and_b32 v48, 0xffff0000, v20
    v_and_b32 v49, 0xffff0000, v21
    v_add_f32 v22, v48, v49
    v_and_b32 v48, 0xffff0000, v55
    v_add_f32 v22, v22, v48
    v_mov_b32 v24, 0
    v_mov_b32 v25, 0
    v_mov_b32 v26, 0
    v_mov_b32 v27, 0
    v_add_f32_dpp v22, v22, v22 row_ror:8 row_mask:0xf bank_mask:0xf
    s_nop 1
    v_add_f32_dpp v22, v22, v22 row_ror:4 row_mask:0xf bank_mask:0xf
    s_nop 1
    v_add_f32_dpp v22, v22, v22 row_ror:2 row_mask:0xf bank_mask:0xf
    s_nop 1
    v_add_f32_dpp v22, v22, v22 row_ror:1 row_mask:0xf bank_mask:0xf
    v_mov_b32 v48, v22
    v_mov_b32 v49, v22
    s_nop 1
    v_permlane16_swap_b32 v48, v49
    v_add_f32 v22, v48, v49
    v_mov_b32 v48, v22
    v_mov_b32 v49, v22
    s_nop 1
    v_permlane32_swap_b32 v48, v49
    v_add_f32 v22, v48, v49
    s_waitcnt vmcnt(15)
    v_and_b32_dpp v28, v20, v10 row_newbcast:0 row_mask:0xf bank_mask:0xf
    v_and_b32_dpp v29, v20, v11 row_newbcast:0 row_mask:0xf bank_mask:0xf
    v_and_b32_dpp v30, v20, v12 row_newbcast:0 row_mask:0xf bank_mask:0xf
    v_and_b32_dpp v31, v20, v13 row_newbcast:0 row_mask:0xf bank_mask:0xf
    s_nop 1
    v_mfma_f32_16x16x32_bf16 v[24:27], v[28:31], v[64:67], v[24:27]
    s_add_u32 s51, s28, 131072
    buffer_load_dwordx4 v[64:67], v7, s[8:11], s51 offen offset:0 nt
    s_waitcnt vmcnt(15)
    v_and_b32_dpp v28, v20, v10 row_newbcast:1 row_mask:0xf bank_mask:0xf
    v_and_b32_dpp v29, v20, v11 row_newbcast:1 row_mask:0xf bank_mask:0xf
    v_and_b32_dpp v30, v20, v12 row_newbcast:1 row_mask:0xf bank_mask:0xf
    v_and_b32_dpp v31, v20, v13 row_newbcast:1 row_mask:0xf bank_mask:0xf
    s_nop 1
    v_mfma_f32_16x16x32_bf16 v[24:27], v[28:31], v[68:71], v[24:27]
    buffer_load_dwordx4 v[68:71], v7, s[8:11], s51 offen offset:1024 nt
    s_waitcnt vmcnt(15)
    v_and_b32_dpp v28, v20, v10 row_newbcast:2 row_mask:0xf bank_mask:0xf
    v_and_b32_dpp v29, v20, v11 row_newbcast:2 row_mask:0xf bank_mask:0xf
    v_and_b32_dpp v30, v20, v12 row_newbcast:2 row_mask:0xf bank_mask:0xf
    v_and_b32_dpp v31, v20, v13 row_newbcast:2 row_mask:0xf bank_mask:0xf
    s_nop 1
    v_mfma_f32_16x16x32_bf16 v[24:27], v[28:31], v[72:75], v[24:27]
    buffer_load_dwordx4 v[72:75], v7, s[8:11], s51 offen offset:2048 nt
    s_waitcnt vmcnt(15)
    v_and_b32_dpp v28, v20, v10 row_newbcast:3 row_mask:0xf bank_mask:0xf
    v_and_b32_dpp v29, v20, v11 row_newbcast:3 row_mask:0xf bank_mask:0xf
    v_and_b32_dpp v30, v20, v12 row_newbcast:3 row_mask:0xf bank_mask:0xf
    v_and_b32_dpp v31, v20, v13 row_newbcast:3 row_mask:0xf bank_mask:0xf
    s_nop 1
    v_mfma_f32_16x16x32_bf16 v[24:27], v[28:31], v[76:79], v[24:27]
    buffer_load_dwordx4 v[76:79], v7, s[8:11], s51 offen offset:3072 nt
    s_waitcnt vmcnt(15)
    v_and_b32_dpp v28, v20, v10 row_newbcast:4 row_mask:0xf bank_mask:0xf
    v_and_b32_dpp v29, v20, v11 row_newbcast:4 row_mask:0xf bank_mask:0xf
    v_and_b32_dpp v30, v20, v12 row_newbcast:4 row_mask:0xf bank_mask:0xf
    v_and_b32_dpp v31, v20, v13 row_newbcast:4 row_mask:0xf bank_mask:0xf
    s_nop 1
    v_mfma_f32_16x16x32_bf16 v[24:27], v[28:31], v[80:83], v[24:27]
    buffer_load_dwordx4 v[80:83], v7, s[8:11], s51 offen offset:256 nt
    s_waitcnt vmcnt(15)
    v_and_b32_dpp v28, v20, v10 row_newbcast:5 row_mask:0xf bank_mask:0xf
    v_and_b32_dpp v29, v20, v11 row_newbcast:5 row_mask:0xf bank_mask:0xf
    v_and_b32_dpp v30, v20, v12 row_newbcast:5 row_mask:0xf bank_mask:0xf
    v_and_b32_dpp v31, v20, v13 row_newbcast:5 row_mask:0xf bank_mask:0xf
    s_nop 1
    v_mfma_f32_16x16x32_bf16 v[24:27], v[28:31], v[84:87], v[24:27]
    buffer_load_dwordx4 v[84:87], v7, s[8:11], s51 offen offset:1280 nt
    s_waitcnt vmcnt(15)
    v_and_b32_dpp v28, v20, v10 row_newbcast:6 row_mask:0xf bank_mask:0xf
    v_and_b32_dpp v29, v20, v11 row_newbcast:6 row_mask:0xf bank_mask:0xf
    v_and_b32_dpp v30, v20, v12 row_newbcast:6 row_mask:0xf bank_mask:0xf
    v_and_b32_dpp v31, v20, v13 row_newbcast:6 row_mask:0xf bank_mask:0xf
    s_nop 1
    v_mfma_f32_16x16x32_bf16 v[24:27], v[28:31], v[88:91], v[24:27]
    buffer_load_dwordx4 v[88:91], v7, s[8:11], s51 offen offset:2304 nt
    s_waitcnt vmcnt(15)
    v_and_b32_dpp v28, v20, v10 row_newbcast:7 row_mask:0xf bank_mask:0xf
    v_and_b32_dpp v29, v20, v11 row_newbcast:7 row_mask:0xf bank_mask:0xf
    v_and_b32_dpp v30, v20, v12 row_newbcast:7 row_mask:0xf bank_mask:0xf
    v_and_b32_dpp v31, v20, v13 row_newbcast:7 row_mask:0xf bank_mask:0xf
    s_nop 1
    v_mfma_f32_16x16x32_bf16 v[24:27], v[28:31], v[92:95], v[24:27]
    buffer_load_dwordx4 v[92:95], v7, s[8:11], s51 offen offset:3328 nt
    s_waitcnt vmcnt(15)
    v_and_b32_dpp v28, v20, v10 row_newbcast:8 row_mask:0xf bank_mask:0xf
    v_and_b32_dpp v29, v20, v11 row_newbcast:8 row_mask:0xf bank_mask:0xf
    v_and_b32_dpp v30, v20, v12 row_newbcast:8 row_mask:0xf bank_mask:0xf
    v_and_b32_dpp v31, v20, v13 row_newbcast:8 row_mask:0xf bank_mask:0xf
    s_nop 1
    v_mfma_f32_16x16x32_bf16 v[24:27], v[28:31], v[96:99], v[24:27]
    buffer_load_dwordx4 v[96:99], v7, s[8:11], s51 offen offset:512 nt
    s_waitcnt vmcnt(15)
    v_and_b32_dpp v28, v20, v10 row_newbcast:9 row_mask:0xf bank_mask:0xf
    v_and_b32_dpp v29, v20, v11 row_newbcast:9 row_mask:0xf bank_mask:0xf
    v_and_b32_dpp v30, v20, v12 row_newbcast:9 row_mask:0xf bank_mask:0xf
    v_and_b32_dpp v31, v20, v13 row_newbcast:9 row_mask:0xf bank_mask:0xf
    s_nop 1
    v_mfma_f32_16x16x32_bf16 v[24:27], v[28:31], v[100:103], v[24:27]
    buffer_load_dwordx4 v[100:103], v7, s[8:11], s51 offen offset:1536 nt
    s_waitcnt vmcnt(15)
    v_and_b32_dpp v28, v20, v10 row_newbcast:10 row_mask:0xf bank_mask:0xf
    v_and_b32_dpp v29, v20, v11 row_newbcast:10 row_mask:0xf bank_mask:0xf
    v_and_b32_dpp v30, v20, v12 row_newbcast:10 row_mask:0xf bank_mask:0xf
    v_and_b32_dpp v31, v20, v13 row_newbcast:10 row_mask:0xf bank_mask:0xf
    s_nop 1
    v_mfma_f32_16x16x32_bf16 v[24:27], v[28:31], v[104:107], v[24:27]
    buffer_load_dwordx4 v[104:107], v7, s[8:11], s51 offen offset:2560 nt
    s_waitcnt vmcnt(15)
    v_and_b32_dpp v28, v20, v10 row_newbcast:11 row_mask:0xf bank_mask:0xf
    v_and_b32_dpp v29, v20, v11 row_newbcast:11 row_mask:0xf bank_mask:0xf
    v_and_b32_dpp v30, v20, v12 row_newbcast:11 row_mask:0xf bank_mask:0xf
    v_and_b32_dpp v31, v20, v13 row_newbcast:11 row_mask:0xf bank_mask:0xf
    s_nop 1
    v_mfma_f32_16x16x32_bf16 v[24:27], v[28:31], v[108:111], v[24:27]
    buffer_load_dwordx4 v[108:111], v7, s[8:11], s51 offen offset:3584 nt
    s_waitcnt vmcnt(15)
    v_and_b32_dpp v28, v20, v10 row_newbcast:12 row_mask:0xf bank_mask:0xf
    v_and_b32_dpp v29, v20, v11 row_newbcast:12 row_mask:0xf bank_mask:0xf
    v_and_b32_dpp v30, v20, v12 row_newbcast:12 row_mask:0xf bank_mask:0xf
    v_and_b32_dpp v31, v20, v13 row_newbcast:12 row_mask:0xf bank_mask:0xf
    s_nop 1
    v_mfma_f32_16x16x32_bf16 v[24:27], v[28:31], v[112:115], v[24:27]
    buffer_load_dwordx4 v[112:115], v7, s[8:11], s51 offen offset:768 nt
    s_waitcnt vmcnt(15)
    v_and_b32_dpp v28, v20, v10 row_newbcast:13 row_mask:0xf bank_mask:0xf
    v_and_b32_dpp v29, v20, v11 row_newbcast:13 row_mask:0xf bank_mask:0xf
    v_and_b32_dpp v30, v20, v12 row_newbcast:13 row_mask:0xf bank_mask:0xf
    v_and_b32_dpp v31, v20, v13 row_newbcast:13 row_mask:0xf bank_mask:0xf
    s_nop 1
    v_mfma_f32_16x16x32_bf16 v[24:27], v[28:31], v[116:119], v[24:27]
    buffer_load_dwordx4 v[116:119], v7, s[8:11], s51 offen offset:1792 nt
    s_waitcnt vmcnt(15)
    v_and_b32_dpp v28, v20, v10 row_newbcast:14 row_mask:0xf bank_mask:0xf
    v_and_b32_dpp v29, v20, v11 row_newbcast:14 row_mask:0xf bank_mask:0xf
    v_and_b32_dpp v30, v20, v12 row_newbcast:14 row_mask:0xf bank_mask:0xf
    v_and_b32_dpp v31, v20, v13 row_newbcast:14 row_mask:0xf bank_mask:0xf
    s_nop 1
    v_mfma_f32_16x16x32_bf16 v[24:27], v[28:31], v[120:123], v[24:27]
    buffer_load_dwordx4 v[120:123], v7, s[8:11], s51 offen offset:2816 nt
    s_waitcnt vmcnt(15)
    v_and_b32_dpp v28, v20, v10 row_newbcast:15 row_mask:0xf bank_mask:0xf
    v_and_b32_dpp v29, v20, v11 row_newbcast:15 row_mask:0xf bank_mask:0xf
    v_and_b32_dpp v30, v20, v12 row_newbcast:15 row_mask:0xf bank_mask:0xf
    v_and_b32_dpp v31, v20, v13 row_newbcast:15 row_mask:0xf bank_mask:0xf
    s_nop 1
    v_mfma_f32_16x16x32_bf16 v[24:27], v[28:31], v[124:127], v[24:27]
    buffer_load_dwordx4 v[124:127], v7, s[8:11], s51 offen offset:3840 nt
    s_waitcnt vmcnt(15)
    v_and_b32_dpp v28, v21, v10 row_newbcast:0 row_mask:0xf bank_mask:0xf
    v_and_b32_dpp v29, v21, v11 row_newbcast:0 row_mask:0xf bank_mask:0xf
    v_and_b32_dpp v30, v21, v12 row_newbcast:0 row_mask:0xf bank_mask:0xf
    v_and_b32_dpp v31, v21, v13 row_newbcast:0 row_mask:0xf bank_mask:0xf
    s_nop 1
    v_mfma_f32_16x16x32_bf16 v[24:27], v[28:31], v[64:67], v[24:27]
    s_add_u32 s51, s28, 262144
    buffer_load_dwordx4 v[64:67], v7, s[8:11], s51 offen offset:0 nt
    s_waitcnt vmcnt(15)
    v_and_b32_dpp v28, v21, v10 row_newbcast:1 row_mask:0xf bank_mask:0xf
    v_and_b32_dpp v29, v21, v11 row_newbcast:1 row_mask:0xf bank_mask:0xf
    v_and_b32_dpp v30, v21, v12 row_newbcast:1 row_mask:0xf bank_mask:0xf
    v_and_b32_dpp v31, v21, v13 row_newbcast:1 row_mask:0xf bank_mask:0xf
    s_nop 1
    v_mfma_f32_16x16x32_bf16 v[24:27], v[28:31], v[68:71], v[24:27]
    buffer_load_dwordx4 v[68:71], v7, s[8:11], s51 offen offset:1024 nt
    s_waitcnt vmcnt(15)
    v_and_b32_dpp v28, v21, v10 row_newbcast:2 row_mask:0xf bank_mask:0xf
    v_and_b32_dpp v29, v21, v11 row_newbcast:2 row_mask:0xf bank_mask:0xf
    v_and_b32_dpp v30, v21, v12 row_newbcast:2 row_mask:0xf bank_mask:0xf
    v_and_b32_dpp v31, v21, v13 row_newbcast:2 row_mask:0xf bank_mask:0xf
    s_nop 1
    v_mfma_f32_16x16x32_bf16 v[24:27], v[28:31], v[72:75], v[24:27]
    buffer_load_dwordx4 v[72:75], v7, s[8:11], s51 offen offset:2048 nt
    s_waitcnt vmcnt(15)
    v_and_b32_dpp v28, v21, v10 row_newbcast:3 row_mask:0xf bank_mask:0xf
    v_and_b32_dpp v29, v21, v11 row_newbcast:3 row_mask:0xf bank_mask:0xf
    v_and_b32_dpp v30, v21, v12 row_newbcast:3 row_mask:0xf bank_mask:0xf
    v_and_b32_dpp v31, v21, v13 row_newbcast:3 row_mask:0xf bank_mask:0xf
    s_nop 1
    v_mfma_f32_16x16x32_bf16 v[24:27], v[28:31], v[76:79], v[24:27]
    buffer_load_dwordx4 v[76:79], v7, s[8:11], s51 offen offset:3072 nt
    s_waitcnt vmcnt(15)
    v_and_b32_dpp v28, v21, v10 row_newbcast:4 row_mask:0xf bank_mask:0xf
    v_and_b32_dpp v29, v21, v11 row_newbcast:4 row_mask:0xf bank_mask:0xf
    v_and_b32_dpp v30, v21, v12 row_newbcast:4 row_mask:0xf bank_mask:0xf
    v_and_b32_dpp v31, v21, v13 row_newbcast:4 row_mask:0xf bank_mask:0xf
    s_nop 1
    v_mfma_f32_16x16x32_bf16 v[24:27], v[28:31], v[80:83], v[24:27]
    buffer_load_dwordx4 v[80:83], v7, s[8:11], s51 offen offset:256 nt
    s_waitcnt vmcnt(15)
    v_and_b32_dpp v28, v21, v10 row_newbcast:5 row_mask:0xf bank_mask:0xf
    v_and_b32_dpp v29, v21, v11 row_newbcast:5 row_mask:0xf bank_mask:0xf
    v_and_b32_dpp v30, v21, v12 row_newbcast:5 row_mask:0xf bank_mask:0xf
    v_and_b32_dpp v31, v21, v13 row_newbcast:5 row_mask:0xf bank_mask:0xf
    s_nop 1
    v_mfma_f32_16x16x32_bf16 v[24:27], v[28:31], v[84:87], v[24:27]
    buffer_load_dwordx4 v[84:87], v7, s[8:11], s51 offen offset:1280 nt
    s_waitcnt vmcnt(15)
    v_and_b32_dpp v28, v21, v10 row_newbcast:6 row_mask:0xf bank_mask:0xf
    v_and_b32_dpp v29, v21, v11 row_newbcast:6 row_mask:0xf bank_mask:0xf
    v_and_b32_dpp v30, v21, v12 row_newbcast:6 row_mask:0xf bank_mask:0xf
    v_and_b32_dpp v31, v21, v13 row_newbcast:6 row_mask:0xf bank_mask:0xf
    s_nop 1
    v_mfma_f32_16x16x32_bf16 v[24:27], v[28:31], v[88:91], v[24:27]
    buffer_load_dwordx4 v[88:91], v7, s[8:11], s51 offen offset:2304 nt
    s_waitcnt vmcnt(15)
    v_and_b32_dpp v28, v21, v10 row_newbcast:7 row_mask:0xf bank_mask:0xf
    v_and_b32_dpp v29, v21, v11 row_newbcast:7 row_mask:0xf bank_mask:0xf
    v_and_b32_dpp v30, v21, v12 row_newbcast:7 row_mask:0xf bank_mask:0xf
    v_and_b32_dpp v31, v21, v13 row_newbcast:7 row_mask:0xf bank_mask:0xf
    s_nop 1
    v_mfma_f32_16x16x32_bf16 v[24:27], v[28:31], v[92:95], v[24:27]
    buffer_load_dwordx4 v[92:95], v7, s[8:11], s51 offen offset:3328 nt
    s_waitcnt vmcnt(15)
    v_and_b32_dpp v28, v21, v10 row_newbcast:8 row_mask:0xf bank_mask:0xf
    v_and_b32_dpp v29, v21, v11 row_newbcast:8 row_mask:0xf bank_mask:0xf
    v_and_b32_dpp v30, v21, v12 row_newbcast:8 row_mask:0xf bank_mask:0xf
    v_and_b32_dpp v31, v21, v13 row_newbcast:8 row_mask:0xf bank_mask:0xf
    s_nop 1
    v_mfma_f32_16x16x32_bf16 v[24:27], v[28:31], v[96:99], v[24:27]
    buffer_load_dwordx4 v[96:99], v7, s[8:11], s51 offen offset:512 nt
    s_waitcnt vmcnt(15)
    v_and_b32_dpp v28, v21, v10 row_newbcast:9 row_mask:0xf bank_mask:0xf
    v_and_b32_dpp v29, v21, v11 row_newbcast:9 row_mask:0xf bank_mask:0xf
    v_and_b32_dpp v30, v21, v12 row_newbcast:9 row_mask:0xf bank_mask:0xf
    v_and_b32_dpp v31, v21, v13 row_newbcast:9 row_mask:0xf bank_mask:0xf
    s_nop 1
    v_mfma_f32_16x16x32_bf16 v[24:27], v[28:31], v[100:103], v[24:27]
    buffer_load_dwordx4 v[100:103], v7, s[8:11], s51 offen offset:1536 nt
    s_waitcnt vmcnt(15)
    v_and_b32_dpp v28, v21, v10 row_newbcast:10 row_mask:0xf bank_mask:0xf
    v_and_b32_dpp v29, v21, v11 row_newbcast:10 row_mask:0xf bank_mask:0xf
    v_and_b32_dpp v30, v21, v12 row_newbcast:10 row_mask:0xf bank_mask:0xf
    v_and_b32_dpp v31, v21, v13 row_newbcast:10 row_mask:0xf bank_mask:0xf
    s_nop 1
    v_mfma_f32_16x16x32_bf16 v[24:27], v[28:31], v[104:107], v[24:27]
    buffer_load_dwordx4 v[104:107], v7, s[8:11], s51 offen offset:2560 nt
    s_waitcnt vmcnt(15)
    v_and_b32_dpp v28, v21, v10 row_newbcast:11 row_mask:0xf bank_mask:0xf
    v_and_b32_dpp v29, v21, v11 row_newbcast:11 row_mask:0xf bank_mask:0xf
    v_and_b32_dpp v30, v21, v12 row_newbcast:11 row_mask:0xf bank_mask:0xf
    v_and_b32_dpp v31, v21, v13 row_newbcast:11 row_mask:0xf bank_mask:0xf
    s_nop 1
    v_mfma_f32_16x16x32_bf16 v[24:27], v[28:31], v[108:111], v[24:27]
    buffer_load_dwordx4 v[108:111], v7, s[8:11], s51 offen offset:3584 nt
    s_waitcnt vmcnt(15)
    v_and_b32_dpp v28, v21, v10 row_newbcast:12 row_mask:0xf bank_mask:0xf
    v_and_b32_dpp v29, v21, v11 row_newbcast:12 row_mask:0xf bank_mask:0xf
    v_and_b32_dpp v30, v21, v12 row_newbcast:12 row_mask:0xf bank_mask:0xf
    v_and_b32_dpp v31, v21, v13 row_newbcast:12 row_mask:0xf bank_mask:0xf
    s_nop 1
    v_mfma_f32_16x16x32_bf16 v[24:27], v[28:31], v[112:115], v[24:27]
    buffer_load_dwordx4 v[112:115], v7, s[8:11], s51 offen offset:768 nt
    s_waitcnt vmcnt(15)
    v_and_b32_dpp v28, v21, v10 row_newbcast:13 row_mask:0xf bank_mask:0xf
    v_and_b32_dpp v29, v21, v11 row_newbcast:13 row_mask:0xf bank_mask:0xf
    v_and_b32_dpp v30, v21, v12 row_newbcast:13 row_mask:0xf bank_mask:0xf
    v_and_b32_dpp v31, v21, v13 row_newbcast:13 row_mask:0xf bank_mask:0xf
    s_nop 1
    v_mfma_f32_16x16x32_bf16 v[24:27], v[28:31], v[116:119], v[24:27]
    buffer_load_dwordx4 v[116:119], v7, s[8:11], s51 offen offset:1792 nt
    s_waitcnt vmcnt(15)
    v_and_b32_dpp v28, v21, v10 row_newbcast:14 row_mask:0xf bank_mask:0xf
    v_and_b32_dpp v29, v21, v11 row_newbcast:14 row_mask:0xf bank_mask:0xf
    v_and_b32_dpp v30, v21, v12 row_newbcast:14 row_mask:0xf bank_mask:0xf
    v_and_b32_dpp v31, v21, v13 row_newbcast:14 row_mask:0xf bank_mask:0xf
    s_nop 1
    v_mfma_f32_16x16x32_bf16 v[24:27], v[28:31], v[120:123], v[24:27]
    buffer_load_dwordx4 v[120:123], v7, s[8:11], s51 offen offset:2816 nt
    s_waitcnt vmcnt(15)
    v_and_b32_dpp v28, v21, v10 row_newbcast:15 row_mask:0xf bank_mask:0xf
    v_and_b32_dpp v29, v21, v11 row_newbcast:15 row_mask:0xf bank_mask:0xf
    v_and_b32_dpp v30, v21, v12 row_newbcast:15 row_mask:0xf bank_mask:0xf
    v_and_b32_dpp v31, v21, v13 row_newbcast:15 row_mask:0xf bank_mask:0xf
    s_nop 1
    v_mfma_f32_16x16x32_bf16 v[24:27], v[28:31], v[124:127], v[24:27]
    buffer_load_dwordx4 v[124:127], v7, s[8:11], s51 offen offset:3840 nt
    s_waitcnt vmcnt(15)
    v_and_b32_dpp v28, v55, v10 row_newbcast:0 row_mask:0xf bank_mask:0xf
    v_and_b32_dpp v29, v55, v11 row_newbcast:0 row_mask:0xf bank_mask:0xf
    v_and_b32_dpp v30, v55, v12 row_newbcast:0 row_mask:0xf bank_mask:0xf
    v_and_b32_dpp v31, v55, v13 row_newbcast:0 row_mask:0xf bank_mask:0xf
    s_nop 1
    v_mfma_f32_16x16x32_bf16 v[24:27], v[28:31], v[64:67], v[24:27]
    s_waitcnt vmcnt(14)
    v_and_b32_dpp v28, v55, v10 row_newbcast:1 row_mask:0xf bank_mask:0xf
    v_and_b32_dpp v29, v55, v11 row_newbcast:1 row_mask:0xf bank_mask:0xf
    v_and_b32_dpp v30, v55, v12 row_newbcast:1 row_mask:0xf bank_mask:0xf
    v_and_b32_dpp v31, v55, v13 row_newbcast:1 row_mask:0xf bank_mask:0xf
    s_nop 1
    v_mfma_f32_16x16x32_bf16 v[24:27], v[28:31], v[68:71], v[24:27]
    s_waitcnt vmcnt(13)
    v_and_b32_dpp v28, v55, v10 row_newbcast:2 row_mask:0xf bank_mask:0xf
    v_and_b32_dpp v29, v55, v11 row_newbcast:2 row_mask:0xf bank_mask:0xf
    v_and_b32_dpp v30, v55, v12 row_newbcast:2 row_mask:0xf bank_mask:0xf
    v_and_b32_dpp v31, v55, v13 row_newbcast:2 row_mask:0xf bank_mask:0xf
    s_nop 1
    v_mfma_f32_16x16x32_bf16 v[24:27], v[28:31], v[72:75], v[24:27]
    s_waitcnt vmcnt(12)
    v_and_b32_dpp v28, v55, v10 row_newbcast:3 row_mask:0xf bank_mask:0xf
    v_and_b32_dpp v29, v55, v11 row_newbcast:3 row_mask:0xf bank_mask:0xf
    v_and_b32_dpp v30, v55, v12 row_newbcast:3 row_mask:0xf bank_mask:0xf
    v_and_b32_dpp v31, v55, v13 row_newbcast:3 row_mask:0xf bank_mask:0xf
    s_nop 1
    v_mfma_f32_16x16x32_bf16 v[24:27], v[28:31], v[76:79], v[24:27]
    s_waitcnt vmcnt(11)
    v_and_b32_dpp v28, v55, v10 row_newbcast:4 row_mask:0xf bank_mask:0xf
    v_and_b32_dpp v29, v55, v11 row_newbcast:4 row_mask:0xf bank_mask:0xf
    v_and_b32_dpp v30, v55, v12 row_newbcast:4 row_mask:0xf bank_mask:0xf
    v_and_b32_dpp v31, v55, v13 row_newbcast:4 row_mask:0xf bank_mask:0xf
    s_nop 1
    v_mfma_f32_16x16x32_bf16 v[24:27], v[28:31], v[80:83], v[24:27]
    s_waitcnt vmcnt(10)
    v_and_b32_dpp v28, v55, v10 row_newbcast:5 row_mask:0xf bank_mask:0xf
    v_and_b32_dpp v29, v55, v11 row_newbcast:5 row_mask:0xf bank_mask:0xf
    v_and_b32_dpp v30, v55, v12 row_newbcast:5 row_mask:0xf bank_mask:0xf
    v_and_b32_dpp v31, v55, v13 row_newbcast:5 row_mask:0xf bank_mask:0xf
    s_nop 1
    v_mfma_f32_16x16x32_bf16 v[24:27], v[28:31], v[84:87], v[24:27]
    s_waitcnt vmcnt(9)
    v_and_b32_dpp v28, v55, v10 row_newbcast:6 row_mask:0xf bank_mask:0xf
    v_and_b32_dpp v29, v55, v11 row_newbcast:6 row_mask:0xf bank_mask:0xf
    v_and_b32_dpp v30, v55, v12 row_newbcast:6 row_mask:0xf bank_mask:0xf
    v_and_b32_dpp v31, v55, v13 row_newbcast:6 row_mask:0xf bank_mask:0xf
    s_nop 1
    v_mfma_f32_16x16x32_bf16 v[24:27], v[28:31], v[88:91], v[24:27]
    s_waitcnt vmcnt(8)
    v_and_b32_dpp v28, v55, v10 row_newbcast:7 row_mask:0xf bank_mask:0xf
    v_and_b32_dpp v29, v55, v11 row_newbcast:7 row_mask:0xf bank_mask:0xf
    v_and_b32_dpp v30, v55, v12 row_newbcast:7 row_mask:0xf bank_mask:0xf
    v_and_b32_dpp v31, v55, v13 row_newbcast:7 row_mask:0xf bank_mask:0xf
    s_nop 1
    v_mfma_f32_16x16x32_bf16 v[24:27], v[28:31], v[92:95], v[24:27]
    s_waitcnt vmcnt(7)
    v_and_b32_dpp v28, v55, v10 row_newbcast:8 row_mask:0xf bank_mask:0xf
    v_and_b32_dpp v29, v55, v11 row_newbcast:8 row_mask:0xf bank_mask:0xf
    v_and_b32_dpp v30, v55, v12 row_newbcast:8 row_mask:0xf bank_mask:0xf
    v_and_b32_dpp v31, v55, v13 row_newbcast:8 row_mask:0xf bank_mask:0xf
    s_nop 1
    v_mfma_f32_16x16x32_bf16 v[24:27], v[28:31], v[96:99], v[24:27]
    s_waitcnt vmcnt(6)
    v_and_b32_dpp v28, v55, v10 row_newbcast:9 row_mask:0xf bank_mask:0xf
    v_and_b32_dpp v29, v55, v11 row_newbcast:9 row_mask:0xf bank_mask:0xf
    v_and_b32_dpp v30, v55, v12 row_newbcast:9 row_mask:0xf bank_mask:0xf
    v_and_b32_dpp v31, v55, v13 row_newbcast:9 row_mask:0xf bank_mask:0xf
    s_nop 1
    v_mfma_f32_16x16x32_bf16 v[24:27], v[28:31], v[100:103], v[24:27]
    s_waitcnt vmcnt(5)
    v_and_b32_dpp v28, v55, v10 row_newbcast:10 row_mask:0xf bank_mask:0xf
    v_and_b32_dpp v29, v55, v11 row_newbcast:10 row_mask:0xf bank_mask:0xf
    v_and_b32_dpp v30, v55, v12 row_newbcast:10 row_mask:0xf bank_mask:0xf
    v_and_b32_dpp v31, v55, v13 row_newbcast:10 row_mask:0xf bank_mask:0xf
    s_nop 1
    v_mfma_f32_16x16x32_bf16 v[24:27], v[28:31], v[104:107], v[24:27]
    s_waitcnt vmcnt(4)
    v_and_b32_dpp v28, v55, v10 row_newbcast:11 row_mask:0xf bank_mask:0xf
    v_and_b32_dpp v29, v55, v11 row_newbcast:11 row_mask:0xf bank_mask:0xf
    v_and_b32_dpp v30, v55, v12 row_newbcast:11 row_mask:0xf bank_mask:0xf
    v_and_b32_dpp v31, v55, v13 row_newbcast:11 row_mask:0xf bank_mask:0xf
    s_nop 1
    v_mfma_f32_16x16x32_bf16 v[24:27], v[28:31], v[108:111], v[24:27]
    s_waitcnt vmcnt(3)
    v_and_b32_dpp v28, v55, v10 row_newbcast:12 row_mask:0xf bank_mask:0xf
    v_and_b32_dpp v29, v55, v11 row_newbcast:12 row_mask:0xf bank_mask:0xf
    v_and_b32_dpp v30, v55, v12 row_newbcast:12 row_mask:0xf bank_mask:0xf
    v_and_b32_dpp v31, v55, v13 row_newbcast:12 row_mask:0xf bank_mask:0xf
    s_nop 1
    v_mfma_f32_16x16x32_bf16 v[24:27], v[28:31], v[112:115], v[24:27]
    s_waitcnt vmcnt(2)
    v_and_b32_dpp v28, v55, v10 row_newbcast:13 row_mask:0xf bank_mask:0xf
    v_and_b32_dpp v29, v55, v11 row_newbcast:13 row_mask:0xf bank_mask:0xf
    v_and_b32_dpp v30, v55, v12 row_newbcast:13 row_mask:0xf bank_mask:0xf
    v_and_b32_dpp v31, v55, v13 row_newbcast:13 row_mask:0xf bank_mask:0xf
    s_nop 1
    v_mfma_f32_16x16x32_bf16 v[24:27], v[28:31], v[116:119], v[24:27]
    s_waitcnt vmcnt(1)
    v_and_b32_dpp v28, v55, v10 row_newbcast:14 row_mask:0xf bank_mask:0xf
    v_and_b32_dpp v29, v55, v11 row_newbcast:14 row_mask:0xf bank_mask:0xf
    v_and_b32_dpp v30, v55, v12 row_newbcast:14 row_mask:0xf bank_mask:0xf
    v_and_b32_dpp v31, v55, v13 row_newbcast:14 row_mask:0xf bank_mask:0xf
    s_nop 1
    v_mfma_f32_16x16x32_bf16 v[24:27], v[28:31], v[120:123], v[24:27]
    s_waitcnt vmcnt(0)
    v_and_b32_dpp v28, v55, v10 row_newbcast:15 row_mask:0xf bank_mask:0xf
    v_and_b32_dpp v29, v55, v11 row_newbcast:15 row_mask:0xf bank_mask:0xf
    v_and_b32_dpp v30, v55, v12 row_newbcast:15 row_mask:0xf bank_mask:0xf
    v_and_b32_dpp v31, v55, v13 row_newbcast:15 row_mask:0xf bank_mask:0xf
    s_nop 1
    v_mfma_f32_16x16x32_bf16 v[24:27], v[28:31], v[124:127], v[24:27]
    v_lshlrev_b32 v48, 5, v3
    v_lshl_add_u32 v48, v2, 4, v48
    s_lshl_b32 s31, s24, 9
    v_add_u32 v49, s31, v48
    s_lshl_b32 s31, s24, 3
    v_mov_b32 v50, s31
    v_mov_b32 v52, v23
    v_mov_b32 v53, v22
    s_mov_b32 exec_lo, -1
    s_mov_b32 exec_hi, 0
    ds_write_b128 v49, v[24:27] offset:6144
    s_mov_b64 exec, 1
    ds_write_b64 v50, v[52:53] offset:10240
    s_mov_b64 exec, -1
    s_waitcnt lgkmcnt(0)
    s_barrier
    s_cmp_lg_u32 s24, 0
    s_cbranch_scc1 A_done_3
    v_mov_b32 v50, 0
    ds_read_b128 v[64:67], v50 offset:10240
    ds_read_b128 v[68:71], v50 offset:10256
    ds_read_b128 v[72:75], v50 offset:10272
    ds_read_b128 v[76:79], v50 offset:10288
    ds_read_b128 v[80:83], v48 offset:6144
    ds_read_b128 v[84:87], v48 offset:6656
    ds_read_b128 v[88:91], v48 offset:7168
    ds_read_b128 v[92:95], v48 offset:7680
    ds_read_b128 v[96:99], v48 offset:8192
    ds_read_b128 v[100:103], v48 offset:8704
    ds_read_b128 v[104:107], v48 offset:9216
    ds_read_b128 v[108:111], v48 offset:9728
    s_waitcnt lgkmcnt(0)
    v_max3_f32 v56, v64, v66, v68
    v_max3_f32 v56, v56, v70, v72
    v_max3_f32 v56, v56, v74, v76
    v_max_f32 v56, v56, v78
    v_sub_f32 v64, v64, v56
    v_exp_f32 v64, v64
    v_sub_f32 v66, v66, v56
    v_exp_f32 v66, v66
    v_sub_f32 v68, v68, v56
    v_exp_f32 v68, v68
    v_sub_f32 v70, v70, v56
    v_exp_f32 v70, v70
    v_sub_f32 v72, v72, v56
    v_exp_f32 v72, v72
    v_sub_f32 v74, v74, v56
    v_exp_f32 v74, v74
    v_sub_f32 v76, v76, v56
    v_exp_f32 v76, v76
    v_sub_f32 v78, v78, v56
    v_exp_f32 v78, v78
    v_mul_f32 v57, v64, v65
    v_fmac_f32 v57, v66, v67
    v_fmac_f32 v57, v68, v69
    v_fmac_f32 v57, v70, v71
    v_fmac_f32 v57, v72, v73
    v_fmac_f32 v57, v74, v75
    v_fmac_f32 v57, v76, v77
    v_fmac_f32 v57, v78, v79
    v_mul_f32 v60, v64, v80
    v_mul_f32 v61, v64, v81
    v_mul_f32 v62, v64, v82
    v_mul_f32 v63, v64, v83
    v_fmac_f32 v60, v66, v84
    v_fmac_f32 v61, v66, v85
    v_fmac_f32 v62, v66, v86
    v_fmac_f32 v63, v66, v87
    v_fmac_f32 v60, v68, v88
    v_fmac_f32 v61, v68, v89
    v_fmac_f32 v62, v68, v90
    v_fmac_f32 v63, v68, v91
    v_fmac_f32 v60, v70, v92
    v_fmac_f32 v61, v70, v93
    v_fmac_f32 v62, v70, v94
    v_fmac_f32 v63, v70, v95
    v_fmac_f32 v60, v72, v96
    v_fmac_f32 v61, v72, v97
    v_fmac_f32 v62, v72, v98
    v_fmac_f32 v63, v72, v99
    v_fmac_f32 v60, v74, v100
    v_fmac_f32 v61, v74, v101
    v_fmac_f32 v62, v74, v102
    v_fmac_f32 v63, v74, v103
    v_fmac_f32 v60, v76, v104
    v_fmac_f32 v61, v76, v105
    v_fmac_f32 v62, v76, v106
    v_fmac_f32 v63, v76, v107
    v_fmac_f32 v60, v78, v108
    v_fmac_f32 v61, v78, v109
    v_fmac_f32 v62, v78, v110
    v_fmac_f32 v63, v78, v111
    s_lshl_b32 s31, s53, 10
    s_add_u32 s31, s31, 0
    s_mov_b32 exec_lo, -1
    s_mov_b32 exec_hi, 0
    buffer_store_dwordx4 v[60:63], v48, s[20:23], s31 offen sc1
    s_mov_b64 exec, 1
    buffer_store_dwordx2 v[56:57], v50, s[20:23], s31 offen offset:512 sc1
    s_waitcnt vmcnt(0)
    v_mov_b32 v49, 1
    s_lshl_b32 s31, s25, 2
    buffer_atomic_add v49, v50, s[56:59], s31 offen offset:64
    s_mov_b64 exec, -1
A_done_3:
main_end:
    s_endpgm
.section .rodata,"a"
.p2align 6
.amdhsa_kernel main_kernel
  .amdhsa_next_free_vgpr 256
  .amdhsa_next_free_sgpr 102
  .amdhsa_accum_offset 256
  .amdhsa_group_segment_fixed_size 0
  .amdhsa_kernarg_size 112
  .amdhsa_user_sgpr_count 2
  .amdhsa_user_sgpr_kernarg_segment_ptr 1
  .amdhsa_system_sgpr_workgroup_id_x 1
.end_amdhsa_kernel
```
